```python
import torch

def _softmax(x, axis=-1):
    return torch.softmax(x, dim=axis)
def _gelu(x):
    return torch.nn.functional.gelu(x, approximate="tanh")
def _silu(x):
    return torch.nn.functional.silu(x)
def _sigmoid(x):
    return torch.sigmoid(x)
def _layernorm(x, axis=-1, eps=1e-5):
    m = x.mean(dim=axis, keepdim=True)
    v = x.var(dim=axis, keepdim=True, unbiased=False)
    return (x - m) / torch.sqrt(v + eps)
def _scatter_add(tgt, idx, src, axis=0):
    return tgt.clone().index_add_(axis, idx, src)
def _segment_sum(src, seg, n):
    out = torch.zeros((n,) + src.shape[1:], dtype=src.dtype)
    return out.index_add_(0, seg, src)
def _pad(x, pw):
    flat = tuple(v for pair in reversed(pw) for v in pair)
    return torch.nn.functional.pad(x, flat)

kernel_name = 'gated_mix__sliding_block__softmax_full_mha__prompt'

def setup_inputs():

    _w = (lambda a: (lambda t: t.to(torch.bfloat16) if t.is_floating_point() else t)(torch.as_tensor(a)))
    def _A_setup():
        B, S, D = 1, 2048, 576
        return {
            "x": _w((lambda *s: torch.randn(*s, dtype=torch.bfloat16) * 0.05)(B, S, D)),
            "wqkv": _w((lambda *s: torch.randn(*s, dtype=torch.bfloat16) * 3.2)(D, 3 * D)),
            "wo": _w((lambda *s: torch.randn(*s, dtype=torch.bfloat16) * 0.1)(D, D)),
        }
    _A_in = _A_setup()

    def _B_setup():
        B, S, D = 1, 2048, 576
        return {
            "x": _w((lambda *s: torch.randn(*s, dtype=torch.bfloat16) * 0.05)(B, S, D)),
            "wqkv": _w((lambda *s: torch.randn(*s, dtype=torch.bfloat16) * 1.6)(D, 3 * D)),
            "wo": _w((lambda *s: torch.randn(*s, dtype=torch.bfloat16) * 0.2)(D, D)),
        }
    _B_in = _B_setup()

    return {
        "A_x": _A_in["x"],
        "A_wqkv": _A_in["wqkv"],
        "A_wo": _A_in["wo"],
        "B_x": _B_in["x"],
        "B_wqkv": _B_in["wqkv"],
        "B_wo": _B_in["wo"],
        "gate_w": _w((lambda *s: torch.randn(*s, dtype=torch.bfloat16) * 0.05)(576) * 16.0),
    }

def reference(A_x, A_wqkv, A_wo, B_x, B_wqkv, B_wo, gate_w):
    def _A_ref(x, wqkv, wo):
        B, S, D = x.shape
        H = 32; Dh = D // H; W = 256
        qkv = (lambda x, *d: x.permute(*d))((x @ wqkv).reshape(B, S, 3, H, Dh), 2, 0, 3, 1, 4)
        q, k, v = qkv[0], qkv[1], qkv[2]
        scores = torch.einsum("bhqd,bhkd->bhqk", q, k) * (Dh ** -0.5)
        idx = torch.arange(S)
        mask = (idx[:, None] - idx[None, :] >= 0) & (idx[:, None] - idx[None, :] < W)
        scores = torch.where(mask[None, None], scores, -1e9)
        p = _softmax(scores, axis=-1)
        o = torch.einsum("bhqk,bhkd->bhqd", p, v)
        return (lambda x, *d: x.permute(*d))(o, 0, 2, 1, 3).reshape(B, S, D) @ wo

    def _B_ref(x, wqkv, wo):
        B, S, D = x.shape
        H = 32; Dh = D // H
        qkv = (lambda x, *d: x.permute(*d))((x @ wqkv).reshape(B, S, 3, H, Dh), 2, 0, 3, 1, 4)
        q, k, v = qkv[0], qkv[1], qkv[2]
        scale = Dh ** -0.5
        scores = torch.einsum("bhqd,bhkd->bhqk", q, k) * scale
        p = _softmax(scores, axis=-1)
        o = torch.einsum("bhqk,bhkd->bhqd", p, v)
        return (lambda x, *d: x.permute(*d))(o, 0, 2, 1, 3).reshape(B, S, D) @ wo

    x = A_x
    g = _sigmoid((x * gate_w).sum(-1, keepdims=True))
    a = _A_ref(x, A_wqkv, A_wo)
    b = _B_ref(x, B_wqkv, B_wo)
    return g * a + (1 - g) * b
```

```asm
; @launch kernel=k1_qkv_kernel grid=(224,1,1) block=(896,1,1) lds=147456
; @launch kernel=k2_attn_kernel grid=(256,1,1) block=(640,1,1) lds=155712
; @launch kernel=k3_out_kernel grid=(216,1,1) block=(512,1,1) lds=147456
.amdgcn_target "amdgcn-amd-amdhsa--gfx950"
.text
.globl k1_qkv_kernel
.p2align 8
.type k1_qkv_kernel,@function
k1_qkv_kernel:
    s_cmp_ge_u32 s2, 224
    s_cbranch_scc1 k1_qkv_kernel_end
    s_load_dwordx4 s[4:7], s[0:1], 0
    s_load_dwordx2 s[44:45], s[0:1], 32
    s_load_dwordx2 s[46:47], s[0:1], 48
    s_load_dwordx2 s[48:49], s[0:1], 72
    v_and_b32 v1, 63, v0
    v_lshrrev_b32 v12, 6, v0
    s_and_b32 s36, s2, 7
    v_readfirstlane_b32 s26, v12
    s_lshr_b32 s37, s2, 3
    s_lshr_b32 s38, s36, 2
    s_lshl_b32 s38, s38, 2
    s_and_b32 s39, s37, 3
    s_add_u32 s25, s38, s39
    s_and_b32 s38, s36, 3
    s_mul_i32 s38, s38, 7
    s_lshr_b32 s39, s37, 2
    s_add_u32 s24, s38, s39
    s_cmp_ge_u32 s24, 27
    s_cbranch_scc1 k1_qkv_kernel_end
    s_cmp_ge_u32 s26, 8
    s_cbranch_scc0 k1_qkv_kernel_comp
    s_cmp_ge_u32 s26, 12
    s_cbranch_scc1 k1_qkv_kernel_ldw
    s_sub_u32 s39, s26, 8
    v_lshrrev_b32 v12, 3, v1
    s_lshl_b32 s36, s39, 3
    v_add_u32 v12, s36, v12
    v_mul_u32_u24 v2, 1152, v12
    v_lshrrev_b32 v13, 4, v1
    s_and_b32 s36, s39, 1
    s_lshl_b32 s36, s36, 2
    v_add_u32 v13, s36, v13
    v_and_b32 v14, 7, v1
    v_xor_b32 v14, v14, v13
    v_lshl_add_u32 v2, v14, 4, v2
    s_lshr_b32 s36, s2, 5
    s_mul_i32 s36, s36, 37
    s_mul_i32 s37, s39, 10
    s_add_u32 s36, s36, s37
    v_lshrrev_b32 v15, 1, v1
    v_add_u32 v15, s36, v15
    v_min_u32 v15, 255, v15
    v_mul_u32_u24 v3, 1152, v15
    v_and_b32 v15, 1, v1
    v_lshl_add_u32 v3, v15, 6, v3
    s_mov_b32 s59, 1048575
    s_lshl_b32 s31, s39, 10
    s_mov_b32 s32, 4096
    s_mul_i32 s28, s25, 294912
    s_mov_b32 s29, 36864
    s_mov_b32 s30, 128
    s_waitcnt lgkmcnt(0)
    s_mov_b32 s8, s4
    s_and_b32 s9, s5, 0xffff
    s_mov_b32 s10, 2359296
    s_mov_b32 s11, 0x00020000
    s_mov_b32 s54, 1
    s_branch k1_qkv_kernel_lpx
k1_qkv_kernel_ldw:
    s_sub_u32 s39, s26, 12
    s_lshl_b32 s42, s24, 1
    s_add_u32 s42, s42, s39
    s_cmp_ge_u32 s42, 27
    s_cselect_b32 s43, 1, 0
    s_mul_i32 s36, s43, 27
    s_sub_u32 s50, s42, s36
    v_lshrrev_b32 v12, 3, v1
    v_mul_u32_u24 v2, 3456, v12
    v_bfe_u32 v13, v1, 4, 1
    v_lshlrev_b32 v13, 2, v13
    v_and_b32 v14, 7, v1
    v_xor_b32 v14, v14, v13
    v_lshl_add_u32 v2, v14, 4, v2
    s_and_b32 s36, s25, 3
    s_lshl_b32 s36, s36, 4
    v_lshrrev_b32 v15, 1, v1
    v_add_u32 v15, s36, v15
    v_mul_u32_u24 v3, 3456, v15
    v_and_b32 v15, 1, v1
    v_lshl_add_u32 v3, v15, 6, v3
    s_mov_b32 s59, -1
    s_lshl_b32 s31, s39, 13
    s_add_u32 s31, s31, 32768
    s_mov_b32 s32, 1024
    s_lshl_b32 s28, s50, 7
    s_mov_b32 s29, 27648
    s_mov_b32 s30, 221184
    s_waitcnt lgkmcnt(0)
    s_cmp_eq_u32 s43, 0
    s_cselect_b32 s8, s6, s44
    s_cselect_b32 s9, s7, s45
    s_and_b32 s9, s9, 0xffff
    s_mov_b32 s10, 1990656
    s_mov_b32 s11, 0x00020000
    s_mov_b32 s54, 0
k1_qkv_kernel_lpw:
    s_mov_b32 s33, 0
    s_mov_b32 s27, -2
k1_qkv_kernel_lpw_loop:
    s_cmp_lt_i32 s27, 0
    s_cbranch_scc1 k1_qkv_kernel_lpw_issue
    s_cmp_eq_u32 s27, 8
    s_cbranch_scc1 k1_qkv_kernel_lpw_last
    s_waitcnt vmcnt(8)
    s_barrier
    s_cmp_eq_u32 s27, 7
    s_cbranch_scc1 k1_qkv_kernel_lpw_skip
k1_qkv_kernel_lpw_issue:
    s_add_u32 m0, s33, s31
    s_mov_b32 s37, s28
    buffer_load_dwordx4 v2, s[8:11], s37 offen lds
    s_add_u32 m0, m0, s32
    s_add_u32 s37, s37, s29
    buffer_load_dwordx4 v2, s[8:11], s37 offen lds
    s_add_u32 m0, m0, s32
    s_add_u32 s37, s37, s29
    buffer_load_dwordx4 v2, s[8:11], s37 offen lds
    s_add_u32 m0, m0, s32
    s_add_u32 s37, s37, s29
    buffer_load_dwordx4 v2, s[8:11], s37 offen lds
    s_add_u32 m0, m0, s32
    s_add_u32 s37, s37, s29
    buffer_load_dwordx4 v2, s[8:11], s37 offen lds
    s_add_u32 m0, m0, s32
    s_add_u32 s37, s37, s29
    buffer_load_dwordx4 v2, s[8:11], s37 offen lds
    s_add_u32 m0, m0, s32
    s_add_u32 s37, s37, s29
    buffer_load_dwordx4 v2, s[8:11], s37 offen lds
    s_add_u32 m0, m0, s32
    s_add_u32 s37, s37, s29
    buffer_load_dwordx4 v2, s[8:11], s37 offen lds
    s_add_u32 s28, s28, s30
    s_add_u32 s33, s33, 49152
    s_cmp_eq_u32 s33, 147456
    s_cselect_b32 s33, 0, s33
k1_qkv_kernel_lpw_skip:
    s_add_u32 s27, s27, 1
    s_branch k1_qkv_kernel_lpw_loop
k1_qkv_kernel_lpw_last:
    s_waitcnt vmcnt(0)
    s_barrier
    s_endpgm
k1_qkv_kernel_lpx:
    s_mov_b32 s33, 0
    s_mov_b32 s27, -2
k1_qkv_kernel_lpx_loop:
    s_cmp_lt_i32 s27, 0
    s_cbranch_scc1 k1_qkv_kernel_lpx_issue
    s_cmp_eq_u32 s27, 8
    s_cbranch_scc1 k1_qkv_kernel_lpx_last
    s_waitcnt vmcnt(8)
    s_barrier
    s_cmp_eq_u32 s27, 7
    s_cbranch_scc1 k1_qkv_kernel_lpx_skip
k1_qkv_kernel_lpx_issue:
    s_add_u32 m0, s33, s31
    s_mov_b32 s37, s28
    buffer_load_dwordx4 v2, s[8:11], s37 offen lds
    s_add_u32 m0, m0, s32
    s_add_u32 s37, s37, s29
    buffer_load_dwordx4 v2, s[8:11], s37 offen lds
    s_add_u32 m0, m0, s32
    s_add_u32 s37, s37, s29
    buffer_load_dwordx4 v2, s[8:11], s37 offen lds
    s_add_u32 m0, m0, s32
    s_add_u32 s37, s37, s29
    buffer_load_dwordx4 v2, s[8:11], s37 offen lds
    s_add_u32 m0, m0, s32
    s_add_u32 s37, s37, s29
    buffer_load_dwordx4 v2, s[8:11], s37 offen lds
    s_add_u32 m0, m0, s32
    s_add_u32 s37, s37, s29
    buffer_load_dwordx4 v2, s[8:11], s37 offen lds
    s_add_u32 m0, m0, s32
    s_add_u32 s37, s37, s29
    buffer_load_dwordx4 v2, s[8:11], s37 offen lds
    s_add_u32 m0, m0, s32
    s_add_u32 s37, s37, s29
    buffer_load_dwordx4 v2, s[8:11], s37 offen lds
    s_add_u32 s28, s28, s30
    s_add_u32 s33, s33, 49152
    s_cmp_eq_u32 s33, 147456
    s_cselect_b32 s33, 0, s33
k1_qkv_kernel_lpx_skip:
    s_add_u32 s27, s27, 1
    s_branch k1_qkv_kernel_lpx_loop
k1_qkv_kernel_lpx_last:
    s_waitcnt vmcnt(0)
    s_barrier
    s_endpgm
k1_qkv_kernel_comp:
    s_lshr_b32 s40, s26, 2
    s_and_b32 s41, s26, 3
    s_lshl_b32 s42, s24, 1
    s_add_u32 s42, s42, s40
    s_cmp_ge_u32 s42, 27
    s_cselect_b32 s43, 1, 0
    s_mul_i32 s36, s43, 27
    s_sub_u32 s50, s42, s36
    s_mov_b32 s51, 0
    s_cmp_ge_u32 s50, 9
    s_addc_u32 s51, s51, 0
    s_cmp_ge_u32 s50, 18
    s_addc_u32 s51, s51, 0
    v_mov_b32 v56, 0
    v_mov_b32 v57, 0
    v_mov_b32 v58, 0
    v_mov_b32 v59, 0
    v_mov_b32 v60, 0
    v_mov_b32 v61, 0
    v_mov_b32 v62, 0
    v_mov_b32 v63, 0
    v_mov_b32 v64, 0
    v_mov_b32 v65, 0
    v_mov_b32 v66, 0
    v_mov_b32 v67, 0
    v_mov_b32 v68, 0
    v_mov_b32 v69, 0
    v_mov_b32 v70, 0
    v_mov_b32 v71, 0
    v_mov_b32 v72, 0
    v_mov_b32 v73, 0
    v_mov_b32 v74, 0
    v_mov_b32 v75, 0
    v_mov_b32 v76, 0
    v_mov_b32 v77, 0
    v_mov_b32 v78, 0
    v_mov_b32 v79, 0
    s_waitcnt lgkmcnt(0)
    s_mov_b32 s8, s4
    s_and_b32 s9, s5, 0xffff
    s_mov_b32 s10, 2359296
    s_mov_b32 s11, 0x00020000
    s_mov_b32 s16, s48
    s_and_b32 s17, s49, 0xffff
    s_mov_b32 s18, 23068672
    s_mov_b32 s19, 0x00020000
    s_mov_b32 s20, s46
    s_and_b32 s21, s47, 0xffff
    s_mov_b32 s22, 1152
    s_mov_b32 s23, 0x00020000
    s_mov_b32 s60, s24
    s_cmp_ge_u32 s24, 9
    s_cselect_b32 s60, 99, s60
    s_sub_u32 s36, s24, 14
    s_cmp_lt_u32 s36, 7
    s_cbranch_scc0 k1_qkv_kernel_gsel
    s_add_u32 s60, s36, 9
k1_qkv_kernel_gsel:
    s_cmp_ge_u32 s60, 16
    s_cbranch_scc1 k1_qkv_kernel_nog1
    s_lshl_b32 s36, s25, 8
    s_lshl_b32 s37, s60, 4
    s_add_u32 s36, s36, s37
    s_lshl_b32 s37, s26, 1
    s_add_u32 s52, s36, s37
    s_mul_i32 s36, s52, 1152
    v_lshlrev_b32 v12, 5, v1
    s_bfm_b64 exec, 36, 0
    buffer_load_dwordx4 v[56:59], v12, s[8:11], s36 offen
    buffer_load_dwordx4 v[60:63], v12, s[8:11], s36 offen offset:16
    buffer_load_dwordx4 v[64:67], v12, s[8:11], s36 offen offset:1152
    buffer_load_dwordx4 v[68:71], v12, s[8:11], s36 offen offset:1168
    buffer_load_dwordx4 v[72:75], v12, s[20:23], 0 offen
    buffer_load_dwordx4 v[76:79], v12, s[20:23], 0 offen offset:16
    s_mov_b64 exec, -1
k1_qkv_kernel_nog1:
    v_and_b32 v12, 31, v1
    v_lshrrev_b32 v13, 5, v1
    v_bfe_u32 v14, v1, 1, 3
    v_xor_b32 v14, v14, v13
    v_lshlrev_b32 v14, 4, v14
    s_lshl_b32 s36, s41, 6
    v_add_u32 v12, s36, v12
    v_lshlrev_b32 v12, 7, v12
    v_xor_b32 v15, 0, v14
    v_add_u32 v6, v12, v15
    v_xor_b32 v15, 32, v14
    v_add_u32 v7, v12, v15
    v_xor_b32 v15, 64, v14
    v_add_u32 v8, v12, v15
    v_xor_b32 v15, 96, v14
    v_add_u32 v9, v12, v15
    v_bfe_u32 v14, v1, 2, 2
    v_lshl_add_u32 v15, v13, 3, v14
    v_lshlrev_b32 v15, 7, v15
    v_bfe_u32 v16, v1, 4, 1
    v_lshlrev_b32 v16, 5, v16
    v_and_b32 v17, 3, v1
    v_lshl_add_u32 v16, v17, 3, v16
    v_lshrrev_b32 v14, 1, v14
    v_lshlrev_b32 v14, 6, v14
    v_xor_b32 v16, v16, v14
    s_lshl_b32 s36, s40, 13
    s_add_u32 s36, s36, 32768
    v_add3_u32 v10, v15, v16, s36
    v_xor_b32 v11, 64, v10
    s_lshl_b32 s36, s25, 3
    s_lshl_b32 s37, s41, 1
    s_add_u32 s53, s36, s37
    s_cmp_eq_u32 s51, 2
    s_cbranch_scc1 k1_qkv_kernel_sov
    s_mul_i32 s36, s51, 9
    s_sub_u32 s36, s50, s36
    s_lshl_b32 s36, s36, 4
    s_mul_i32 s37, s51, 4194304
    s_lshl_b32 s38, s43, 21
    s_add_u32 s37, s37, s38
    s_lshl_b32 s38, s53, 10
    s_add_u32 s37, s37, s38
    s_add_u32 s54, s37, 0
    s_mul_i32 s37, s51, 524288
    s_lshl_b32 s38, s43, 18
    s_add_u32 s37, s37, s38
    s_lshl_b32 s38, s53, 8
    s_add_u32 s37, s37, s38
    s_add_u32 s55, s37, 13631488
    v_and_b32 v12, 31, v1
    v_lshlrev_b32 v18, 3, v12
    v_add_u32 v18, s54, v18
    v_lshlrev_b32 v19, 3, v12
    v_add_u32 v19, s55, v19
    v_add_u32 v20, s36, v13
    v_add_u32 v12, 0, v20
    v_mul_u32_u24 v14, 7282, v12
    v_lshrrev_b32 v14, 16, v14
    v_mul_u32_u24 v15, 9, v14
    v_sub_u32 v15, v12, v15
    v_cmp_lt_u32 vcc, 4, v15
    s_nop 1
    v_cndmask_b32 v16, 0, 1, vcc
    v_lshl_add_u32 v17, v14, 1, v16
    v_lshlrev_b32 v17, 16, v17
    v_mul_u32_u24 v16, 5, v16
    v_sub_u32 v16, v15, v16
    v_and_b32 v21, 1, v16
    v_lshl_add_u32 v17, v21, 9, v17
    v_lshrrev_b32 v21, 1, v16
    v_lshl_add_u32 v17, v21, 8, v17
    v_add_u32 v17, v17, v18
    v_lshl_add_u32 v21, v14, 14, v19
    v_cmp_eq_u32 vcc, 4, v15
    s_nop 1
    v_cndmask_b32 v120, v17, v21, vcc
    v_cndmask_b32 v21, 0, 1, vcc
    v_or_b32 v120, v120, v21
    v_add_u32 v12, 2, v20
    v_mul_u32_u24 v14, 7282, v12
    v_lshrrev_b32 v14, 16, v14
    v_mul_u32_u24 v15, 9, v14
    v_sub_u32 v15, v12, v15
    v_cmp_lt_u32 vcc, 4, v15
    s_nop 1
    v_cndmask_b32 v16, 0, 1, vcc
    v_lshl_add_u32 v17, v14, 1, v16
    v_lshlrev_b32 v17, 16, v17
    v_mul_u32_u24 v16, 5, v16
    v_sub_u32 v16, v15, v16
    v_and_b32 v21, 1, v16
    v_lshl_add_u32 v17, v21, 9, v17
    v_lshrrev_b32 v21, 1, v16
    v_lshl_add_u32 v17, v21, 8, v17
    v_add_u32 v17, v17, v18
    v_lshl_add_u32 v21, v14, 14, v19
    v_cmp_eq_u32 vcc, 4, v15
    s_nop 1
    v_cndmask_b32 v121, v17, v21, vcc
    v_cndmask_b32 v21, 0, 1, vcc
    v_or_b32 v121, v121, v21
    v_add_u32 v12, 4, v20
    v_mul_u32_u24 v14, 7282, v12
    v_lshrrev_b32 v14, 16, v14
    v_mul_u32_u24 v15, 9, v14
    v_sub_u32 v15, v12, v15
    v_cmp_lt_u32 vcc, 4, v15
    s_nop 1
    v_cndmask_b32 v16, 0, 1, vcc
    v_lshl_add_u32 v17, v14, 1, v16
    v_lshlrev_b32 v17, 16, v17
    v_mul_u32_u24 v16, 5, v16
    v_sub_u32 v16, v15, v16
    v_and_b32 v21, 1, v16
    v_lshl_add_u32 v17, v21, 9, v17
    v_lshrrev_b32 v21, 1, v16
    v_lshl_add_u32 v17, v21, 8, v17
    v_add_u32 v17, v17, v18
    v_lshl_add_u32 v21, v14, 14, v19
    v_cmp_eq_u32 vcc, 4, v15
    s_nop 1
    v_cndmask_b32 v122, v17, v21, vcc
    v_cndmask_b32 v21, 0, 1, vcc
    v_or_b32 v122, v122, v21
    v_add_u32 v12, 6, v20
    v_mul_u32_u24 v14, 7282, v12
    v_lshrrev_b32 v14, 16, v14
    v_mul_u32_u24 v15, 9, v14
    v_sub_u32 v15, v12, v15
    v_cmp_lt_u32 vcc, 4, v15
    s_nop 1
    v_cndmask_b32 v16, 0, 1, vcc
    v_lshl_add_u32 v17, v14, 1, v16
    v_lshlrev_b32 v17, 16, v17
    v_mul_u32_u24 v16, 5, v16
    v_sub_u32 v16, v15, v16
    v_and_b32 v21, 1, v16
    v_lshl_add_u32 v17, v21, 9, v17
    v_lshrrev_b32 v21, 1, v16
    v_lshl_add_u32 v17, v21, 8, v17
    v_add_u32 v17, v17, v18
    v_lshl_add_u32 v21, v14, 14, v19
    v_cmp_eq_u32 vcc, 4, v15
    s_nop 1
    v_cndmask_b32 v123, v17, v21, vcc
    v_cndmask_b32 v21, 0, 1, vcc
    v_or_b32 v123, v123, v21
    v_add_u32 v12, 8, v20
    v_mul_u32_u24 v14, 7282, v12
    v_lshrrev_b32 v14, 16, v14
    v_mul_u32_u24 v15, 9, v14
    v_sub_u32 v15, v12, v15
    v_cmp_lt_u32 vcc, 4, v15
    s_nop 1
    v_cndmask_b32 v16, 0, 1, vcc
    v_lshl_add_u32 v17, v14, 1, v16
    v_lshlrev_b32 v17, 16, v17
    v_mul_u32_u24 v16, 5, v16
    v_sub_u32 v16, v15, v16
    v_and_b32 v21, 1, v16
    v_lshl_add_u32 v17, v21, 9, v17
    v_lshrrev_b32 v21, 1, v16
    v_lshl_add_u32 v17, v21, 8, v17
    v_add_u32 v17, v17, v18
    v_lshl_add_u32 v21, v14, 14, v19
    v_cmp_eq_u32 vcc, 4, v15
    s_nop 1
    v_cndmask_b32 v124, v17, v21, vcc
    v_cndmask_b32 v21, 0, 1, vcc
    v_or_b32 v124, v124, v21
    v_add_u32 v12, 10, v20
    v_mul_u32_u24 v14, 7282, v12
    v_lshrrev_b32 v14, 16, v14
    v_mul_u32_u24 v15, 9, v14
    v_sub_u32 v15, v12, v15
    v_cmp_lt_u32 vcc, 4, v15
    s_nop 1
    v_cndmask_b32 v16, 0, 1, vcc
    v_lshl_add_u32 v17, v14, 1, v16
    v_lshlrev_b32 v17, 16, v17
    v_mul_u32_u24 v16, 5, v16
    v_sub_u32 v16, v15, v16
    v_and_b32 v21, 1, v16
    v_lshl_add_u32 v17, v21, 9, v17
    v_lshrrev_b32 v21, 1, v16
    v_lshl_add_u32 v17, v21, 8, v17
    v_add_u32 v17, v17, v18
    v_lshl_add_u32 v21, v14, 14, v19
    v_cmp_eq_u32 vcc, 4, v15
    s_nop 1
    v_cndmask_b32 v125, v17, v21, vcc
    v_cndmask_b32 v21, 0, 1, vcc
    v_or_b32 v125, v125, v21
    v_add_u32 v12, 12, v20
    v_mul_u32_u24 v14, 7282, v12
    v_lshrrev_b32 v14, 16, v14
    v_mul_u32_u24 v15, 9, v14
    v_sub_u32 v15, v12, v15
    v_cmp_lt_u32 vcc, 4, v15
    s_nop 1
    v_cndmask_b32 v16, 0, 1, vcc
    v_lshl_add_u32 v17, v14, 1, v16
    v_lshlrev_b32 v17, 16, v17
    v_mul_u32_u24 v16, 5, v16
    v_sub_u32 v16, v15, v16
    v_and_b32 v21, 1, v16
    v_lshl_add_u32 v17, v21, 9, v17
    v_lshrrev_b32 v21, 1, v16
    v_lshl_add_u32 v17, v21, 8, v17
    v_add_u32 v17, v17, v18
    v_lshl_add_u32 v21, v14, 14, v19
    v_cmp_eq_u32 vcc, 4, v15
    s_nop 1
    v_cndmask_b32 v126, v17, v21, vcc
    v_cndmask_b32 v21, 0, 1, vcc
    v_or_b32 v126, v126, v21
    v_add_u32 v12, 14, v20
    v_mul_u32_u24 v14, 7282, v12
    v_lshrrev_b32 v14, 16, v14
    v_mul_u32_u24 v15, 9, v14
    v_sub_u32 v15, v12, v15
    v_cmp_lt_u32 vcc, 4, v15
    s_nop 1
    v_cndmask_b32 v16, 0, 1, vcc
    v_lshl_add_u32 v17, v14, 1, v16
    v_lshlrev_b32 v17, 16, v17
    v_mul_u32_u24 v16, 5, v16
    v_sub_u32 v16, v15, v16
    v_and_b32 v21, 1, v16
    v_lshl_add_u32 v17, v21, 9, v17
    v_lshrrev_b32 v21, 1, v16
    v_lshl_add_u32 v17, v21, 8, v17
    v_add_u32 v17, v17, v18
    v_lshl_add_u32 v21, v14, 14, v19
    v_cmp_eq_u32 vcc, 4, v15
    s_nop 1
    v_cndmask_b32 v127, v17, v21, vcc
    v_cndmask_b32 v21, 0, 1, vcc
    v_or_b32 v127, v127, v21
    s_branch k1_qkv_kernel_sod
k1_qkv_kernel_sov:
    s_sub_u32 s36, s50, 18
    s_lshl_b32 s36, s36, 6
    s_mul_i32 s37, s43, 2621440
    s_mul_i32 s38, s53, 1280
    s_add_u32 s37, s37, s38
    s_add_u32 s54, s37, 8388608
    s_mov_b32 s55, 81920
    s_lshl_b32 s38, s26, 13
    v_and_b32 v12, 31, v1
    v_add_u32 v12, s36, v12
    v_mul_u32_u24 v14, 3641, v12
    v_lshrrev_b32 v14, 16, v14
    v_mul_u32_u24 v16, 18, v14
    v_sub_u32 v16, v12, v16
    v_add_u32 v15, 16, v16
    v_subrev_u32 v17, 18, v15
    v_min_u32 v15, v15, v17
    v_and_b32 v17, 1, v14
    v_cmp_eq_u32 vcc, 1, v17
    s_nop 1
    v_cndmask_b32 v15, v16, v15, vcc
    v_bfe_u32 v16, v15, 2, 2
    v_xor_b32 v16, v16, v13
    v_lshlrev_b32 v16, 4, v16
    v_and_b32 v17, 31, v1
    v_lshl_add_u32 v16, v17, 6, v16
    v_add_u32 v16, s38, v16
    v_add_u32 v120, 0, v16
    v_mov_b32 v126, 0
    v_lshrrev_b32 v12, 2, v1
    v_add_u32 v12, s36, v12
    v_add_u32 v12, 0, v12
    v_mul_u32_u24 v14, 3641, v12
    v_lshrrev_b32 v14, 16, v14
    v_mul_u32_u24 v16, 18, v14
    v_sub_u32 v16, v12, v16
    v_add_u32 v15, 16, v16
    v_subrev_u32 v17, 18, v15
    v_min_u32 v15, v15, v17
    v_and_b32 v17, 1, v14
    v_cmp_eq_u32 vcc, 1, v17
    s_nop 1
    v_cndmask_b32 v15, v16, v15, vcc
    v_mul_lo_u32 v14, v14, s55
    v_lshl_add_u32 v14, v15, 6, v14
    v_and_b32 v16, 3, v1
    v_lshl_add_u32 v14, v16, 4, v14
    v_add_u32 v122, s54, v14
    v_cmp_le_u32 vcc, 16, v15
    s_nop 1
    v_cndmask_b32 v16, 0, 1, vcc
    v_lshl_or_b32 v126, v16, 0, v126
    v_cmp_eq_u32 vcc, 16, v15
    s_nop 1
    v_cndmask_b32 v16, 0, 1, vcc
    v_lshl_or_b32 v126, v16, 2, v126
    v_lshrrev_b32 v12, 2, v1
    v_add_u32 v12, s36, v12
    v_add_u32 v12, 16, v12
    v_mul_u32_u24 v14, 3641, v12
    v_lshrrev_b32 v14, 16, v14
    v_mul_u32_u24 v16, 18, v14
    v_sub_u32 v16, v12, v16
    v_add_u32 v15, 16, v16
    v_subrev_u32 v17, 18, v15
    v_min_u32 v15, v15, v17
    v_and_b32 v17, 1, v14
    v_cmp_eq_u32 vcc, 1, v17
    s_nop 1
    v_cndmask_b32 v15, v16, v15, vcc
    v_mul_lo_u32 v14, v14, s55
    v_lshl_add_u32 v14, v15, 6, v14
    v_and_b32 v16, 3, v1
    v_lshl_add_u32 v14, v16, 4, v14
    v_add_u32 v123, s54, v14
    v_cmp_le_u32 vcc, 16, v15
    s_nop 1
    v_cndmask_b32 v16, 0, 1, vcc
    v_lshl_or_b32 v126, v16, 1, v126
    v_cmp_eq_u32 vcc, 16, v15
    s_nop 1
    v_cndmask_b32 v16, 0, 1, vcc
    v_lshl_or_b32 v126, v16, 3, v126
    v_and_b32 v12, 31, v1
    v_add_u32 v12, s36, v12
    v_add_u32 v12, 32, v12
    v_mul_u32_u24 v14, 3641, v12
    v_lshrrev_b32 v14, 16, v14
    v_mul_u32_u24 v16, 18, v14
    v_sub_u32 v16, v12, v16
    v_add_u32 v15, 16, v16
    v_subrev_u32 v17, 18, v15
    v_min_u32 v15, v15, v17
    v_and_b32 v17, 1, v14
    v_cmp_eq_u32 vcc, 1, v17
    s_nop 1
    v_cndmask_b32 v15, v16, v15, vcc
    v_bfe_u32 v16, v15, 2, 2
    v_xor_b32 v16, v16, v13
    v_lshlrev_b32 v16, 4, v16
    v_and_b32 v17, 31, v1
    v_lshl_add_u32 v16, v17, 6, v16
    v_add_u32 v16, s38, v16
    v_add_u32 v121, 4096, v16
    v_mov_b32 v127, 0
    v_lshrrev_b32 v12, 2, v1
    v_add_u32 v12, s36, v12
    v_add_u32 v12, 32, v12
    v_mul_u32_u24 v14, 3641, v12
    v_lshrrev_b32 v14, 16, v14
    v_mul_u32_u24 v16, 18, v14
    v_sub_u32 v16, v12, v16
    v_add_u32 v15, 16, v16
    v_subrev_u32 v17, 18, v15
    v_min_u32 v15, v15, v17
    v_and_b32 v17, 1, v14
    v_cmp_eq_u32 vcc, 1, v17
    s_nop 1
    v_cndmask_b32 v15, v16, v15, vcc
    v_mul_lo_u32 v14, v14, s55
    v_lshl_add_u32 v14, v15, 6, v14
    v_and_b32 v16, 3, v1
    v_lshl_add_u32 v14, v16, 4, v14
    v_add_u32 v124, s54, v14
    v_cmp_le_u32 vcc, 16, v15
    s_nop 1
    v_cndmask_b32 v16, 0, 1, vcc
    v_lshl_or_b32 v127, v16, 0, v127
    v_cmp_eq_u32 vcc, 16, v15
    s_nop 1
    v_cndmask_b32 v16, 0, 1, vcc
    v_lshl_or_b32 v127, v16, 2, v127
    v_lshrrev_b32 v12, 2, v1
    v_add_u32 v12, s36, v12
    v_add_u32 v12, 48, v12
    v_mul_u32_u24 v14, 3641, v12
    v_lshrrev_b32 v14, 16, v14
    v_mul_u32_u24 v16, 18, v14
    v_sub_u32 v16, v12, v16
    v_add_u32 v15, 16, v16
    v_subrev_u32 v17, 18, v15
    v_min_u32 v15, v15, v17
    v_and_b32 v17, 1, v14
    v_cmp_eq_u32 vcc, 1, v17
    s_nop 1
    v_cndmask_b32 v15, v16, v15, vcc
    v_mul_lo_u32 v14, v14, s55
    v_lshl_add_u32 v14, v15, 6, v14
    v_and_b32 v16, 3, v1
    v_lshl_add_u32 v14, v16, 4, v14
    v_add_u32 v125, s54, v14
    v_cmp_le_u32 vcc, 16, v15
    s_nop 1
    v_cndmask_b32 v16, 0, 1, vcc
    v_lshl_or_b32 v127, v16, 1, v127
    v_cmp_eq_u32 vcc, 16, v15
    s_nop 1
    v_cndmask_b32 v16, 0, 1, vcc
    v_lshl_or_b32 v127, v16, 3, v127
k1_qkv_kernel_sod:
    s_cmp_ge_u32 s60, 16
    s_cbranch_scc1 k1_qkv_kernel_nog2
    s_waitcnt vmcnt(0)
    v_mov_b32 v12, 0
    v_dot2c_f32_bf16 v12, v56, v72
    v_dot2c_f32_bf16 v12, v57, v73
    v_dot2c_f32_bf16 v12, v58, v74
    v_dot2c_f32_bf16 v12, v59, v75
    v_dot2c_f32_bf16 v12, v60, v76
    v_dot2c_f32_bf16 v12, v61, v77
    v_dot2c_f32_bf16 v12, v62, v78
    v_dot2c_f32_bf16 v12, v63, v79
    s_nop 2
    v_add_f32_dpp v12, v12, v12 quad_perm:[1,0,3,2] row_mask:0xf bank_mask:0xf
    s_nop 1
    v_add_f32_dpp v12, v12, v12 quad_perm:[2,3,0,1] row_mask:0xf bank_mask:0xf
    s_nop 1
    v_add_f32_dpp v12, v12, v12 row_half_mirror row_mask:0xf bank_mask:0xf
    s_nop 1
    v_add_f32_dpp v12, v12, v12 row_mirror row_mask:0xf bank_mask:0xf
    s_nop 0
    v_readlane_b32 s56, v12, 0
    v_readlane_b32 s57, v12, 16
    v_readlane_b32 s58, v12, 32
    v_mov_b32 v13, s56
    v_add_f32 v13, s57, v13
    v_add_f32 v13, s58, v13
    v_mul_f32 v13, 3216550459, v13
    v_exp_f32 v13, v13
    s_nop 0
    v_add_f32 v13, 1.0, v13
    v_rcp_f32 v13, v13
    s_lshl_b32 s36, s52, 2
    s_add_u32 s36, s36, 14680064
    v_mov_b32 v14, 0
    s_mov_b64 exec, 1
    buffer_store_dword v13, v14, s[16:19], s36 offen
    s_mov_b64 exec, -1
    v_mov_b32 v12, 0
    v_dot2c_f32_bf16 v12, v64, v72
    v_dot2c_f32_bf16 v12, v65, v73
    v_dot2c_f32_bf16 v12, v66, v74
    v_dot2c_f32_bf16 v12, v67, v75
    v_dot2c_f32_bf16 v12, v68, v76
    v_dot2c_f32_bf16 v12, v69, v77
    v_dot2c_f32_bf16 v12, v70, v78
    v_dot2c_f32_bf16 v12, v71, v79
    s_nop 2
    v_add_f32_dpp v12, v12, v12 quad_perm:[1,0,3,2] row_mask:0xf bank_mask:0xf
    s_nop 1
    v_add_f32_dpp v12, v12, v12 quad_perm:[2,3,0,1] row_mask:0xf bank_mask:0xf
    s_nop 1
    v_add_f32_dpp v12, v12, v12 row_half_mirror row_mask:0xf bank_mask:0xf
    s_nop 1
    v_add_f32_dpp v12, v12, v12 row_mirror row_mask:0xf bank_mask:0xf
    s_nop 0
    v_readlane_b32 s56, v12, 0
    v_readlane_b32 s57, v12, 16
    v_readlane_b32 s58, v12, 32
    v_mov_b32 v13, s56
    v_add_f32 v13, s57, v13
    v_add_f32 v13, s58, v13
    v_mul_f32 v13, 3216550459, v13
    v_exp_f32 v13, v13
    s_nop 0
    v_add_f32 v13, 1.0, v13
    v_rcp_f32 v13, v13
    s_lshl_b32 s36, s52, 2
    s_add_u32 s36, s36, 14680068
    v_mov_b32 v14, 0
    s_mov_b64 exec, 1
    buffer_store_dword v13, v14, s[16:19], s36 offen
    s_mov_b64 exec, -1
k1_qkv_kernel_nog2:
    v_mov_b32 v56, 0
    v_mov_b32 v57, 0
    v_mov_b32 v58, 0
    v_mov_b32 v59, 0
    v_mov_b32 v60, 0
    v_mov_b32 v61, 0
    v_mov_b32 v62, 0
    v_mov_b32 v63, 0
    v_mov_b32 v64, 0
    v_mov_b32 v65, 0
    v_mov_b32 v66, 0
    v_mov_b32 v67, 0
    v_mov_b32 v68, 0
    v_mov_b32 v69, 0
    v_mov_b32 v70, 0
    v_mov_b32 v71, 0
    v_mov_b32 v72, 0
    v_mov_b32 v73, 0
    v_mov_b32 v74, 0
    v_mov_b32 v75, 0
    v_mov_b32 v76, 0
    v_mov_b32 v77, 0
    v_mov_b32 v78, 0
    v_mov_b32 v79, 0
    v_mov_b32 v80, 0
    v_mov_b32 v81, 0
    v_mov_b32 v82, 0
    v_mov_b32 v83, 0
    v_mov_b32 v84, 0
    v_mov_b32 v85, 0
    v_mov_b32 v86, 0
    v_mov_b32 v87, 0
    v_mov_b32 v88, 0
    v_mov_b32 v89, 0
    v_mov_b32 v90, 0
    v_mov_b32 v91, 0
    v_mov_b32 v92, 0
    v_mov_b32 v93, 0
    v_mov_b32 v94, 0
    v_mov_b32 v95, 0
    v_mov_b32 v96, 0
    v_mov_b32 v97, 0
    v_mov_b32 v98, 0
    v_mov_b32 v99, 0
    v_mov_b32 v100, 0
    v_mov_b32 v101, 0
    v_mov_b32 v102, 0
    v_mov_b32 v103, 0
    v_mov_b32 v104, 0
    v_mov_b32 v105, 0
    v_mov_b32 v106, 0
    v_mov_b32 v107, 0
    v_mov_b32 v108, 0
    v_mov_b32 v109, 0
    v_mov_b32 v110, 0
    v_mov_b32 v111, 0
    v_mov_b32 v112, 0
    v_mov_b32 v113, 0
    v_mov_b32 v114, 0
    v_mov_b32 v115, 0
    v_mov_b32 v116, 0
    v_mov_b32 v117, 0
    v_mov_b32 v118, 0
    v_mov_b32 v119, 0
    v_mov_b32 v32, 0
    v_mov_b32 v48, 0
    v_mov_b32 v33, 0
    v_mov_b32 v49, 0
    v_mov_b32 v34, 0
    v_mov_b32 v50, 0
    v_mov_b32 v35, 0
    v_mov_b32 v51, 0
    v_mov_b32 v36, 0
    v_mov_b32 v52, 0
    v_mov_b32 v37, 0
    v_mov_b32 v53, 0
    v_mov_b32 v38, 0
    v_mov_b32 v54, 0
    v_mov_b32 v39, 0
    v_mov_b32 v55, 0
    s_mov_b32 s56, 4294868992
    s_mov_b32 s57, 49152
    s_mov_b32 s27, 0
    s_mov_b32 s35, 0
    s_cmp_eq_u32 s51, 2
    s_cbranch_scc1 k1_qkv_kernel_loop1
.p2align 3
k1_qkv_kernel_loop0:
    s_barrier
    v_mfma_f32_32x32x16_bf16 v[56:71], v[48:51], v[32:35], v[56:71]
    ds_read_b128 v[24:27], v6
    ds_read_b64_tr_b16 v[40:41], v10 offset:0
    v_mfma_f32_32x32x16_bf16 v[72:87], v[48:51], v[36:39], v[72:87]
    ds_read_b64_tr_b16 v[42:43], v10 offset:512
    ds_read_b128 v[28:31], v6 offset:4096
    v_mfma_f32_32x32x16_bf16 v[88:103], v[52:55], v[32:35], v[88:103]
    ds_read_b64_tr_b16 v[44:45], v11 offset:0
    ds_read_b64_tr_b16 v[46:47], v11 offset:512
    v_mfma_f32_32x32x16_bf16 v[104:119], v[52:55], v[36:39], v[104:119]
    s_waitcnt lgkmcnt(2)
    v_mfma_f32_32x32x16_bf16 v[56:71], v[40:43], v[24:27], v[56:71]
    ds_read_b128 v[32:35], v7
    ds_read_b64_tr_b16 v[48:49], v10 offset:2048
    v_mfma_f32_32x32x16_bf16 v[72:87], v[40:43], v[28:31], v[72:87]
    ds_read_b64_tr_b16 v[50:51], v10 offset:2560
    ds_read_b128 v[36:39], v7 offset:4096
    s_waitcnt lgkmcnt(4)
    v_mfma_f32_32x32x16_bf16 v[88:103], v[44:47], v[24:27], v[88:103]
    ds_read_b64_tr_b16 v[52:53], v11 offset:2048
    ds_read_b64_tr_b16 v[54:55], v11 offset:2560
    v_mfma_f32_32x32x16_bf16 v[104:119], v[44:47], v[28:31], v[104:119]
    s_waitcnt lgkmcnt(2)
    v_mfma_f32_32x32x16_bf16 v[56:71], v[48:51], v[32:35], v[56:71]
    ds_read_b128 v[24:27], v8
    ds_read_b64_tr_b16 v[40:41], v10 offset:4096
    v_mfma_f32_32x32x16_bf16 v[72:87], v[48:51], v[36:39], v[72:87]
    ds_read_b64_tr_b16 v[42:43], v10 offset:4608
    ds_read_b128 v[28:31], v8 offset:4096
    s_waitcnt lgkmcnt(4)
    v_mfma_f32_32x32x16_bf16 v[88:103], v[52:55], v[32:35], v[88:103]
    ds_read_b64_tr_b16 v[44:45], v11 offset:4096
    ds_read_b64_tr_b16 v[46:47], v11 offset:4608
    v_mfma_f32_32x32x16_bf16 v[104:119], v[52:55], v[36:39], v[104:119]
    s_waitcnt lgkmcnt(2)
    v_mfma_f32_32x32x16_bf16 v[56:71], v[40:43], v[24:27], v[56:71]
    ds_read_b128 v[32:35], v9
    ds_read_b64_tr_b16 v[48:49], v10 offset:6144
    v_mfma_f32_32x32x16_bf16 v[72:87], v[40:43], v[28:31], v[72:87]
    ds_read_b64_tr_b16 v[50:51], v10 offset:6656
    ds_read_b128 v[36:39], v9 offset:4096
    s_waitcnt lgkmcnt(4)
    v_mfma_f32_32x32x16_bf16 v[88:103], v[44:47], v[24:27], v[88:103]
    ds_read_b64_tr_b16 v[52:53], v11 offset:6144
    ds_read_b64_tr_b16 v[54:55], v11 offset:6656
    s_add_u32 s35, s35, 1
    s_cmp_eq_u32 s35, 3
    s_cselect_b32 s34, s56, s57
    s_cselect_b32 s35, 0, s35
    v_add_u32 v6, s34, v6
    v_add_u32 v7, s34, v7
    v_add_u32 v8, s34, v8
    v_add_u32 v9, s34, v9
    v_add_u32 v10, s34, v10
    v_add_u32 v11, s34, v11
    s_add_u32 s27, s27, 1
    s_cmp_lt_u32 s27, 9
    v_mfma_f32_32x32x16_bf16 v[104:119], v[44:47], v[28:31], v[104:119]
    s_waitcnt lgkmcnt(0)
    s_cbranch_scc1 k1_qkv_kernel_loop0
    v_mfma_f32_32x32x16_bf16 v[56:71], v[48:51], v[32:35], v[56:71]
    v_mfma_f32_32x32x16_bf16 v[72:87], v[48:51], v[36:39], v[72:87]
    v_mfma_f32_32x32x16_bf16 v[88:103], v[52:55], v[32:35], v[88:103]
    v_mfma_f32_32x32x16_bf16 v[104:119], v[52:55], v[36:39], v[104:119]
    s_nop 15
    s_branch k1_qkv_kernel_epi0
.p2align 3
k1_qkv_kernel_loop1:
    s_barrier
    v_mfma_f32_32x32x16_bf16 v[56:71], v[32:35], v[48:51], v[56:71]
    ds_read_b128 v[24:27], v6
    ds_read_b64_tr_b16 v[40:41], v10 offset:0
    v_mfma_f32_32x32x16_bf16 v[72:87], v[36:39], v[48:51], v[72:87]
    ds_read_b64_tr_b16 v[42:43], v10 offset:512
    ds_read_b128 v[28:31], v6 offset:4096
    v_mfma_f32_32x32x16_bf16 v[88:103], v[32:35], v[52:55], v[88:103]
    ds_read_b64_tr_b16 v[44:45], v11 offset:0
    ds_read_b64_tr_b16 v[46:47], v11 offset:512
    v_mfma_f32_32x32x16_bf16 v[104:119], v[36:39], v[52:55], v[104:119]
    s_waitcnt lgkmcnt(2)
    v_mfma_f32_32x32x16_bf16 v[56:71], v[24:27], v[40:43], v[56:71]
    ds_read_b128 v[32:35], v7
    ds_read_b64_tr_b16 v[48:49], v10 offset:2048
    v_mfma_f32_32x32x16_bf16 v[72:87], v[28:31], v[40:43], v[72:87]
    ds_read_b64_tr_b16 v[50:51], v10 offset:2560
    ds_read_b128 v[36:39], v7 offset:4096
    s_waitcnt lgkmcnt(4)
    v_mfma_f32_32x32x16_bf16 v[88:103], v[24:27], v[44:47], v[88:103]
    ds_read_b64_tr_b16 v[52:53], v11 offset:2048
    ds_read_b64_tr_b16 v[54:55], v11 offset:2560
    v_mfma_f32_32x32x16_bf16 v[104:119], v[28:31], v[44:47], v[104:119]
    s_waitcnt lgkmcnt(2)
    v_mfma_f32_32x32x16_bf16 v[56:71], v[32:35], v[48:51], v[56:71]
    ds_read_b128 v[24:27], v8
    ds_read_b64_tr_b16 v[40:41], v10 offset:4096
    v_mfma_f32_32x32x16_bf16 v[72:87], v[36:39], v[48:51], v[72:87]
    ds_read_b64_tr_b16 v[42:43], v10 offset:4608
    ds_read_b128 v[28:31], v8 offset:4096
    s_waitcnt lgkmcnt(4)
    v_mfma_f32_32x32x16_bf16 v[88:103], v[32:35], v[52:55], v[88:103]
    ds_read_b64_tr_b16 v[44:45], v11 offset:4096
    ds_read_b64_tr_b16 v[46:47], v11 offset:4608
    v_mfma_f32_32x32x16_bf16 v[104:119], v[36:39], v[52:55], v[104:119]
    s_waitcnt lgkmcnt(2)
    v_mfma_f32_32x32x16_bf16 v[56:71], v[24:27], v[40:43], v[56:71]
    ds_read_b128 v[32:35], v9
    ds_read_b64_tr_b16 v[48:49], v10 offset:6144
    v_mfma_f32_32x32x16_bf16 v[72:87], v[28:31], v[40:43], v[72:87]
    ds_read_b64_tr_b16 v[50:51], v10 offset:6656
    ds_read_b128 v[36:39], v9 offset:4096
    s_waitcnt lgkmcnt(4)
    v_mfma_f32_32x32x16_bf16 v[88:103], v[24:27], v[44:47], v[88:103]
    ds_read_b64_tr_b16 v[52:53], v11 offset:6144
    ds_read_b64_tr_b16 v[54:55], v11 offset:6656
    s_add_u32 s35, s35, 1
    s_cmp_eq_u32 s35, 3
    s_cselect_b32 s34, s56, s57
    s_cselect_b32 s35, 0, s35
    v_add_u32 v6, s34, v6
    v_add_u32 v7, s34, v7
    v_add_u32 v8, s34, v8
    v_add_u32 v9, s34, v9
    v_add_u32 v10, s34, v10
    v_add_u32 v11, s34, v11
    s_add_u32 s27, s27, 1
    s_cmp_lt_u32 s27, 9
    v_mfma_f32_32x32x16_bf16 v[104:119], v[28:31], v[44:47], v[104:119]
    s_waitcnt lgkmcnt(0)
    s_cbranch_scc1 k1_qkv_kernel_loop1
    v_mfma_f32_32x32x16_bf16 v[56:71], v[32:35], v[48:51], v[56:71]
    v_mfma_f32_32x32x16_bf16 v[72:87], v[36:39], v[48:51], v[72:87]
    v_mfma_f32_32x32x16_bf16 v[88:103], v[32:35], v[52:55], v[88:103]
    v_mfma_f32_32x32x16_bf16 v[104:119], v[36:39], v[52:55], v[104:119]
    s_nop 15
    s_branch k1_qkv_kernel_epi1
k1_qkv_kernel_epi0:
    s_mov_b32 s36, 1.0
    s_cmp_eq_u32 s51, 0
    s_cselect_b32 s36, 1051597459, s36
    v_and_b32 v12, 1, v120
    v_xor_b32 v120, v120, v12
    v_mul_u32_u24 v12, 768, v12
    v_sub_u32 v13, 1024, v12
    v_add_u32 v13, v13, v120
    v_and_b32 v12, 1, v121
    v_xor_b32 v121, v121, v12
    v_mul_u32_u24 v12, 768, v12
    v_sub_u32 v14, 1024, v12
    v_add_u32 v14, v14, v121
    v_and_b32 v12, 1, v122
    v_xor_b32 v122, v122, v12
    v_mul_u32_u24 v12, 768, v12
    v_sub_u32 v15, 1024, v12
    v_add_u32 v15, v15, v122
    v_and_b32 v12, 1, v123
    v_xor_b32 v123, v123, v12
    v_mul_u32_u24 v12, 768, v12
    v_sub_u32 v16, 1024, v12
    v_add_u32 v16, v16, v123
    v_and_b32 v12, 1, v124
    v_xor_b32 v124, v124, v12
    v_mul_u32_u24 v12, 768, v12
    v_sub_u32 v17, 1024, v12
    v_add_u32 v17, v17, v124
    v_and_b32 v12, 1, v125
    v_xor_b32 v125, v125, v12
    v_mul_u32_u24 v12, 768, v12
    v_sub_u32 v18, 1024, v12
    v_add_u32 v18, v18, v125
    v_and_b32 v12, 1, v126
    v_xor_b32 v126, v126, v12
    v_mul_u32_u24 v12, 768, v12
    v_sub_u32 v19, 1024, v12
    v_add_u32 v19, v19, v126
    v_and_b32 v12, 1, v127
    v_xor_b32 v127, v127, v12
    v_mul_u32_u24 v12, 768, v12
    v_sub_u32 v20, 1024, v12
    v_add_u32 v20, v20, v127
    s_cmp_eq_u32 s51, 0
    s_cbranch_scc0 k1_qkv_kernel_nomul
    v_mul_f32 v56, s36, v56
    v_mul_f32 v57, s36, v57
    v_mul_f32 v58, s36, v58
    v_mul_f32 v59, s36, v59
    v_mul_f32 v60, s36, v60
    v_mul_f32 v61, s36, v61
    v_mul_f32 v62, s36, v62
    v_mul_f32 v63, s36, v63
    v_mul_f32 v64, s36, v64
    v_mul_f32 v65, s36, v65
    v_mul_f32 v66, s36, v66
    v_mul_f32 v67, s36, v67
    v_mul_f32 v68, s36, v68
    v_mul_f32 v69, s36, v69
    v_mul_f32 v70, s36, v70
    v_mul_f32 v71, s36, v71
    v_mul_f32 v72, s36, v72
    v_mul_f32 v73, s36, v73
    v_mul_f32 v74, s36, v74
    v_mul_f32 v75, s36, v75
    v_mul_f32 v76, s36, v76
    v_mul_f32 v77, s36, v77
    v_mul_f32 v78, s36, v78
    v_mul_f32 v79, s36, v79
    v_mul_f32 v80, s36, v80
    v_mul_f32 v81, s36, v81
    v_mul_f32 v82, s36, v82
    v_mul_f32 v83, s36, v83
    v_mul_f32 v84, s36, v84
    v_mul_f32 v85, s36, v85
    v_mul_f32 v86, s36, v86
    v_mul_f32 v87, s36, v87
    v_mul_f32 v88, s36, v88
    v_mul_f32 v89, s36, v89
    v_mul_f32 v90, s36, v90
    v_mul_f32 v91, s36, v91
    v_mul_f32 v92, s36, v92
    v_mul_f32 v93, s36, v93
    v_mul_f32 v94, s36, v94
    v_mul_f32 v95, s36, v95
    v_mul_f32 v96, s36, v96
    v_mul_f32 v97, s36, v97
    v_mul_f32 v98, s36, v98
    v_mul_f32 v99, s36, v99
    v_mul_f32 v100, s36, v100
    v_mul_f32 v101, s36, v101
    v_mul_f32 v102, s36, v102
    v_mul_f32 v103, s36, v103
    v_mul_f32 v104, s36, v104
    v_mul_f32 v105, s36, v105
    v_mul_f32 v106, s36, v106
    v_mul_f32 v107, s36, v107
    v_mul_f32 v108, s36, v108
    v_mul_f32 v109, s36, v109
    v_mul_f32 v110, s36, v110
    v_mul_f32 v111, s36, v111
    v_mul_f32 v112, s36, v112
    v_mul_f32 v113, s36, v113
    v_mul_f32 v114, s36, v114
    v_mul_f32 v115, s36, v115
    v_mul_f32 v116, s36, v116
    v_mul_f32 v117, s36, v117
    v_mul_f32 v118, s36, v118
    v_mul_f32 v119, s36, v119
k1_qkv_kernel_nomul:
    v_cvt_pk_bf16_f32 v24, v56, v57
    v_cvt_pk_bf16_f32 v25, v58, v59
    v_cvt_pk_bf16_f32 v26, v60, v61
    v_cvt_pk_bf16_f32 v27, v62, v63
    v_cvt_pk_bf16_f32 v28, v64, v65
    v_cvt_pk_bf16_f32 v29, v66, v67
    v_cvt_pk_bf16_f32 v30, v68, v69
    v_cvt_pk_bf16_f32 v31, v70, v71
    buffer_store_dwordx2 v[24:25], v120, s[16:19], 0 offen sc1
    buffer_store_dwordx2 v[26:27], v121, s[16:19], 0 offen sc1
    buffer_store_dwordx2 v[28:29], v122, s[16:19], 0 offen sc1
    buffer_store_dwordx2 v[30:31], v123, s[16:19], 0 offen sc1
    v_cvt_pk_bf16_f32 v32, v72, v73
    v_cvt_pk_bf16_f32 v33, v74, v75
    v_cvt_pk_bf16_f32 v34, v76, v77
    v_cvt_pk_bf16_f32 v35, v78, v79
    v_cvt_pk_bf16_f32 v36, v80, v81
    v_cvt_pk_bf16_f32 v37, v82, v83
    v_cvt_pk_bf16_f32 v38, v84, v85
    v_cvt_pk_bf16_f32 v39, v86, v87
    buffer_store_dwordx2 v[32:33], v13, s[16:19], 0 offen sc1
    buffer_store_dwordx2 v[34:35], v14, s[16:19], 0 offen sc1
    buffer_store_dwordx2 v[36:37], v15, s[16:19], 0 offen sc1
    buffer_store_dwordx2 v[38:39], v16, s[16:19], 0 offen sc1
    v_cvt_pk_bf16_f32 v40, v88, v89
    v_cvt_pk_bf16_f32 v41, v90, v91
    v_cvt_pk_bf16_f32 v42, v92, v93
    v_cvt_pk_bf16_f32 v43, v94, v95
    v_cvt_pk_bf16_f32 v44, v96, v97
    v_cvt_pk_bf16_f32 v45, v98, v99
    v_cvt_pk_bf16_f32 v46, v100, v101
    v_cvt_pk_bf16_f32 v47, v102, v103
    buffer_store_dwordx2 v[40:41], v124, s[16:19], 0 offen sc1
    buffer_store_dwordx2 v[42:43], v125, s[16:19], 0 offen sc1
    buffer_store_dwordx2 v[44:45], v126, s[16:19], 0 offen sc1
    buffer_store_dwordx2 v[46:47], v127, s[16:19], 0 offen sc1
    v_cvt_pk_bf16_f32 v48, v104, v105
    v_cvt_pk_bf16_f32 v49, v106, v107
    v_cvt_pk_bf16_f32 v50, v108, v109
    v_cvt_pk_bf16_f32 v51, v110, v111
    v_cvt_pk_bf16_f32 v52, v112, v113
    v_cvt_pk_bf16_f32 v53, v114, v115
    v_cvt_pk_bf16_f32 v54, v116, v117
    v_cvt_pk_bf16_f32 v55, v118, v119
    buffer_store_dwordx2 v[48:49], v17, s[16:19], 0 offen sc1
    buffer_store_dwordx2 v[50:51], v18, s[16:19], 0 offen sc1
    buffer_store_dwordx2 v[52:53], v19, s[16:19], 0 offen sc1
    buffer_store_dwordx2 v[54:55], v20, s[16:19], 0 offen sc1
    s_branch k1_qkv_kernel_fin
k1_qkv_kernel_epi1:
    v_cvt_pk_bf16_f32 v24, v56, v57
    v_cvt_pk_bf16_f32 v25, v58, v59
    v_cvt_pk_bf16_f32 v26, v60, v61
    v_cvt_pk_bf16_f32 v27, v62, v63
    v_cvt_pk_bf16_f32 v28, v64, v65
    v_cvt_pk_bf16_f32 v29, v66, v67
    v_cvt_pk_bf16_f32 v30, v68, v69
    v_cvt_pk_bf16_f32 v31, v70, v71
    ds_write_b128 v120, v[24:27] offset:0
    v_xor_b32 v12, 32, v120
    ds_write_b128 v12, v[28:31] offset:0
    v_cvt_pk_bf16_f32 v32, v72, v73
    v_cvt_pk_bf16_f32 v33, v74, v75
    v_cvt_pk_bf16_f32 v34, v76, v77
    v_cvt_pk_bf16_f32 v35, v78, v79
    v_cvt_pk_bf16_f32 v36, v80, v81
    v_cvt_pk_bf16_f32 v37, v82, v83
    v_cvt_pk_bf16_f32 v38, v84, v85
    v_cvt_pk_bf16_f32 v39, v86, v87
    ds_write_b128 v120, v[32:35] offset:2048
    v_xor_b32 v12, 32, v120
    ds_write_b128 v12, v[36:39] offset:2048
    v_cvt_pk_bf16_f32 v40, v88, v89
    v_cvt_pk_bf16_f32 v41, v90, v91
    v_cvt_pk_bf16_f32 v42, v92, v93
    v_cvt_pk_bf16_f32 v43, v94, v95
    v_cvt_pk_bf16_f32 v44, v96, v97
    v_cvt_pk_bf16_f32 v45, v98, v99
    v_cvt_pk_bf16_f32 v46, v100, v101
    v_cvt_pk_bf16_f32 v47, v102, v103
    ds_write_b128 v121, v[40:43] offset:0
    v_xor_b32 v12, 32, v121
    ds_write_b128 v12, v[44:47] offset:0
    v_cvt_pk_bf16_f32 v48, v104, v105
    v_cvt_pk_bf16_f32 v49, v106, v107
    v_cvt_pk_bf16_f32 v50, v108, v109
    v_cvt_pk_bf16_f32 v51, v110, v111
    v_cvt_pk_bf16_f32 v52, v112, v113
    v_cvt_pk_bf16_f32 v53, v114, v115
    v_cvt_pk_bf16_f32 v54, v116, v117
    v_cvt_pk_bf16_f32 v55, v118, v119
    ds_write_b128 v121, v[48:51] offset:2048
    v_xor_b32 v12, 32, v121
    ds_write_b128 v12, v[52:55] offset:2048
    s_lshl_b32 s38, s26, 13
    v_lshlrev_b32 v13, 4, v1
    v_add_u32 v13, s38, v13
    s_waitcnt lgkmcnt(0)
    ds_read_b128 v[56:59], v13 offset:0
    ds_read_b128 v[60:63], v13 offset:1024
    ds_read_b128 v[64:67], v13 offset:2048
    ds_read_b128 v[68:71], v13 offset:3072
    ds_read_b128 v[72:75], v13 offset:4096
    ds_read_b128 v[76:79], v13 offset:5120
    ds_read_b128 v[80:83], v13 offset:6144
    ds_read_b128 v[84:87], v13 offset:7168
    s_waitcnt lgkmcnt(7)
    buffer_store_dwordx4 v[56:59], v122, s[16:19], 0 offen offset:0 sc1
    s_waitcnt lgkmcnt(6)
    buffer_store_dwordx4 v[60:63], v123, s[16:19], 0 offen offset:0 sc1
    s_waitcnt lgkmcnt(5)
    buffer_store_dwordx4 v[64:67], v122, s[16:19], 0 offen offset:1280 sc1
    s_waitcnt lgkmcnt(4)
    buffer_store_dwordx4 v[68:71], v123, s[16:19], 0 offen offset:1280 sc1
    s_waitcnt lgkmcnt(3)
    buffer_store_dwordx4 v[72:75], v124, s[16:19], 0 offen offset:0 sc1
    s_waitcnt lgkmcnt(2)
    buffer_store_dwordx4 v[76:79], v125, s[16:19], 0 offen offset:0 sc1
    s_waitcnt lgkmcnt(1)
    buffer_store_dwordx4 v[80:83], v124, s[16:19], 0 offen offset:1280 sc1
    s_waitcnt lgkmcnt(0)
    buffer_store_dwordx4 v[84:87], v125, s[16:19], 0 offen offset:1280 sc1
    v_bfe_u32 v12, v126, 2, 1
    v_mul_u32_u24 v12, 0x3f80, v12
    v_lshl_or_b32 v16, v12, 16, v12
    v_mov_b32 v17, v16
    v_mov_b32 v18, v16
    v_mov_b32 v19, v16
    v_bfe_u32 v12, v126, 0, 1
    v_cmp_eq_u32 vcc, 1, v12
    s_nop 1
    s_and_saveexec_b64 s[58:59], vcc
    s_cbranch_execz k1_qkv_kernel_on00
    buffer_store_dwordx4 v[16:19], v122, s[16:19], 0 offen offset:128 sc1
    buffer_store_dwordx4 v[16:19], v122, s[16:19], 0 offen offset:1408 sc1
k1_qkv_kernel_on00:
    s_mov_b64 exec, s[58:59]
    v_bfe_u32 v12, v126, 3, 1
    v_mul_u32_u24 v12, 0x3f80, v12
    v_lshl_or_b32 v16, v12, 16, v12
    v_mov_b32 v17, v16
    v_mov_b32 v18, v16
    v_mov_b32 v19, v16
    v_bfe_u32 v12, v126, 1, 1
    v_cmp_eq_u32 vcc, 1, v12
    s_nop 1
    s_and_saveexec_b64 s[58:59], vcc
    s_cbranch_execz k1_qkv_kernel_on01
    buffer_store_dwordx4 v[16:19], v123, s[16:19], 0 offen offset:128 sc1
    buffer_store_dwordx4 v[16:19], v123, s[16:19], 0 offen offset:1408 sc1
k1_qkv_kernel_on01:
    s_mov_b64 exec, s[58:59]
    v_bfe_u32 v12, v127, 2, 1
    v_mul_u32_u24 v12, 0x3f80, v12
    v_lshl_or_b32 v16, v12, 16, v12
    v_mov_b32 v17, v16
    v_mov_b32 v18, v16
    v_mov_b32 v19, v16
    v_bfe_u32 v12, v127, 0, 1
    v_cmp_eq_u32 vcc, 1, v12
    s_nop 1
    s_and_saveexec_b64 s[58:59], vcc
    s_cbranch_execz k1_qkv_kernel_on10
    buffer_store_dwordx4 v[16:19], v124, s[16:19], 0 offen offset:128 sc1
    buffer_store_dwordx4 v[16:19], v124, s[16:19], 0 offen offset:1408 sc1
k1_qkv_kernel_on10:
    s_mov_b64 exec, s[58:59]
    v_bfe_u32 v12, v127, 3, 1
    v_mul_u32_u24 v12, 0x3f80, v12
    v_lshl_or_b32 v16, v12, 16, v12
    v_mov_b32 v17, v16
    v_mov_b32 v18, v16
    v_mov_b32 v19, v16
    v_bfe_u32 v12, v127, 1, 1
    v_cmp_eq_u32 vcc, 1, v12
    s_nop 1
    s_and_saveexec_b64 s[58:59], vcc
    s_cbranch_execz k1_qkv_kernel_on11
    buffer_store_dwordx4 v[16:19], v125, s[16:19], 0 offen offset:128 sc1
    buffer_store_dwordx4 v[16:19], v125, s[16:19], 0 offen offset:1408 sc1
k1_qkv_kernel_on11:
    s_mov_b64 exec, s[58:59]
k1_qkv_kernel_fin:
k1_qkv_kernel_end:
    s_endpgm

.globl k2_attn_kernel
.p2align 8
.type k2_attn_kernel,@function
k2_attn_kernel:
    s_cmp_ge_u32 s2, 256
    s_cbranch_scc1 k2_attn_kernel_end
    s_load_dwordx2 s[4:5], s[0:1], 72
    v_and_b32 v1, 63, v0
    v_lshrrev_b32 v10, 6, v0
    s_and_b32 s16, s2, 7
    v_readfirstlane_b32 s14, v10
    s_lshr_b32 s17, s2, 3
    s_lshl_b32 s16, s16, 2
    s_and_b32 s18, s17, 3
    s_add_u32 s12, s16, s18
    s_lshr_b32 s13, s17, 2
    v_lshlrev_b32 v2, 4, v1
    s_lshl_b32 s16, s12, 16
    s_add_u32 s24, s16, 4194304
    s_mul_i32 s16, s12, 81920
    s_add_u32 s25, s16, 8388608
    s_lshr_b32 s16, s12, 1
    s_lshl_b32 s16, s16, 14
    s_add_u32 s26, s16, 14155776
    v_mov_b32 v157, 155648
    s_and_b32 s16, s12, 1
    s_lshl_b32 s16, s16, 2
    v_lshlrev_b32 v163, 3, v1
    v_add_u32 v163, s16, v163
    s_cmp_ge_u32 s14, 8
    s_cbranch_scc1 k2_attn_kernel_loader
    s_lshl_b32 s15, s13, 3
    s_add_u32 s15, s15, s14
    s_cmp_lg_u32 s14, 0
    s_cbranch_scc1 k2_attn_kernel_noinit
    v_mov_b32 v13, 0
    v_lshlrev_b32 v14, 2, v1
    v_add_u32 v14, 155648, v14
    s_mov_b64 exec, 0xffff
    ds_write_b32 v14, v13
    s_mov_b64 exec, -1
k2_attn_kernel_noinit:
    v_and_b32 v10, 31, v1
    v_lshlrev_b32 v11, 3, v10
    s_lshl_b32 s16, s12, 16
    s_lshl_b32 s17, s15, 10
    s_add_u32 s40, s16, s17
    s_lshr_b32 s18, s12, 1
    s_lshl_b32 s18, s18, 14
    s_and_b32 s17, s12, 1
    s_lshl_b32 s17, s17, 2
    s_add_u32 s41, s18, s17
    s_lshl_b32 s17, s15, 8
    s_add_u32 s41, s41, s17
    s_add_u32 s41, s41, 13631488
    s_waitcnt lgkmcnt(0)
    s_mov_b32 s8, s4
    s_and_b32 s9, s5, 0xffff
    s_mov_b32 s10, 23068672
    s_mov_b32 s11, 0x00020000
    s_add_u32 s16, s40, 2097152
    v_lshrrev_b32 v12, 5, v1
    v_lshl_add_u32 v34, v12, 8, v11
    buffer_load_dwordx2 v[28:29], v34, s[8:11], s16 offen
    buffer_load_dwordx2 v[30:31], v34, s[8:11], s16 offen offset:512
    s_add_u32 s16, s41, 262144
    buffer_load_dword v32, v11, s[8:11], s16 offen
    s_lshl_b32 s34, s14, 10
    s_lshl_b32 s16, s13, 13
    s_add_u32 s16, s16, s24
    s_add_u32 s16, s16, 2097152
    s_add_u32 s16, s16, s34
    s_mov_b32 m0, s34
    s_mul_i32 s17, s13, 10240
    buffer_load_dwordx4 v2, s[8:11], s16 offen lds
    s_add_u32 s17, s17, s25
    s_add_u32 s17, s17, 2621440
    s_add_u32 s16, s17, s34
    s_add_u32 m0, s34, 65536
    s_nop 0
    buffer_load_dwordx4 v2, s[8:11], s16 offen lds
    s_cmp_lt_u32 s14, 2
    s_cbranch_scc0 k2_attn_kernel_g0x
    s_add_u32 s16, s16, 8192
    s_add_u32 m0, s34, 73728
    s_nop 0
    buffer_load_dwordx4 v2, s[8:11], s16 offen lds
    s_branch k2_attn_kernel_g0e
k2_attn_kernel_g0x:
    s_cmp_lt_u32 s14, 6
    s_cbranch_scc0 k2_attn_kernel_g0e
    s_lshl_b32 s16, s13, 11
    s_add_u32 s16, s16, s26
    s_add_u32 s16, s16, 262144
    s_sub_u32 s18, s14, 2
    s_lshl_b32 s17, s18, 9
    s_add_u32 s16, s16, s17
    s_lshl_b32 s18, s18, 8
    s_add_u32 m0, s18, 147456
    s_nop 0
    buffer_load_dword v163, s[8:11], s16 offen lds
k2_attn_kernel_g0e:
    s_barrier
    v_lshrrev_b32 v11, 5, v1
    v_bfe_u32 v12, v10, 2, 2
    v_xor_b32 v12, v12, v11
    v_min_u32 v13, 19, v10
    v_lshlrev_b32 v158, 6, v13
    v_lshl_add_u32 v158, v12, 4, v158
    v_xor_b32 v162, 32, v158
    v_add_u32 v7, 65536, v158
    v_add_u32 v161, 65536, v162
    v_cmp_gt_u32 vcc, 19, v10
    v_mov_b32 v13, 0x40000
    s_nop 0
    v_cndmask_b32 v7, v13, v7, vcc
    v_cndmask_b32 v161, v13, v161, vcc
    v_lshlrev_b32 v6, 3, v10
    v_lshl_add_u32 v6, v11, 8, v6
    s_and_b32 s16, s12, 1
    s_lshl_b32 s16, s16, 2
    v_lshlrev_b32 v159, 3, v10
    v_add_u32 v159, s16, v159
    v_lshlrev_b32 v8, 2, v10
    v_add_u32 v8, 147456, v8
    v_cmp_gt_u32 vcc, 32, v1
    s_nop 1
    v_cndmask_b32 v8, v13, v8, vcc
    v_mov_b32 v41, 0x3f80
    v_mov_b32 v49, 0x3f80
    v_lshlrev_b32 v14, 2, v11
    v_sub_u32 v14, v10, v14
    s_mov_b32 s29, 4048155338
    v_subrev_u32 v15, 0, v14
    v_ashrrev_i32 v15, 31, v15
    v_and_b32 v140, s29, v15
    v_xor_b32 v124, s29, v140
    v_subrev_u32 v15, 1, v14
    v_ashrrev_i32 v15, 31, v15
    v_and_b32 v141, s29, v15
    v_xor_b32 v125, s29, v141
    v_subrev_u32 v15, 2, v14
    v_ashrrev_i32 v15, 31, v15
    v_and_b32 v142, s29, v15
    v_xor_b32 v126, s29, v142
    v_subrev_u32 v15, 3, v14
    v_ashrrev_i32 v15, 31, v15
    v_and_b32 v143, s29, v15
    v_xor_b32 v127, s29, v143
    v_subrev_u32 v15, 8, v14
    v_ashrrev_i32 v15, 31, v15
    v_and_b32 v144, s29, v15
    v_xor_b32 v128, s29, v144
    v_subrev_u32 v15, 9, v14
    v_ashrrev_i32 v15, 31, v15
    v_and_b32 v145, s29, v15
    v_xor_b32 v129, s29, v145
    v_subrev_u32 v15, 10, v14
    v_ashrrev_i32 v15, 31, v15
    v_and_b32 v146, s29, v15
    v_xor_b32 v130, s29, v146
    v_subrev_u32 v15, 11, v14
    v_ashrrev_i32 v15, 31, v15
    v_and_b32 v147, s29, v15
    v_xor_b32 v131, s29, v147
    v_subrev_u32 v15, 16, v14
    v_ashrrev_i32 v15, 31, v15
    v_and_b32 v148, s29, v15
    v_xor_b32 v132, s29, v148
    v_subrev_u32 v15, 17, v14
    v_ashrrev_i32 v15, 31, v15
    v_and_b32 v149, s29, v15
    v_xor_b32 v133, s29, v149
    v_subrev_u32 v15, 18, v14
    v_ashrrev_i32 v15, 31, v15
    v_and_b32 v150, s29, v15
    v_xor_b32 v134, s29, v150
    v_subrev_u32 v15, 19, v14
    v_ashrrev_i32 v15, 31, v15
    v_and_b32 v151, s29, v15
    v_xor_b32 v135, s29, v151
    v_subrev_u32 v15, 24, v14
    v_ashrrev_i32 v15, 31, v15
    v_and_b32 v152, s29, v15
    v_xor_b32 v136, s29, v152
    v_subrev_u32 v15, 25, v14
    v_ashrrev_i32 v15, 31, v15
    v_and_b32 v153, s29, v15
    v_xor_b32 v137, s29, v153
    v_subrev_u32 v15, 26, v14
    v_ashrrev_i32 v15, 31, v15
    v_and_b32 v154, s29, v15
    v_xor_b32 v138, s29, v154
    v_subrev_u32 v15, 27, v14
    v_ashrrev_i32 v15, 31, v15
    v_and_b32 v155, s29, v15
    v_xor_b32 v139, s29, v155
    s_waitcnt vmcnt(0)
    s_barrier
    v_cmp_gt_u32 vcc, 32, v1
    v_mov_b32 v16, 1065353216
    s_nop 0
    v_cndmask_b32 v32, 0, v32, vcc
    v_cndmask_b32 v33, 0, v16, vcc
    v_and_b32 v10, 31, v1
    v_lshlrev_b32 v12, 2, v10
    s_lshl_b32 s16, s15, 7
    s_add_u32 s16, s16, 14680064
    buffer_load_dword v9, v12, s[8:11], s16 offen
    s_lshr_b32 s52, s12, 1
    s_lshl_b32 s52, s52, 14
    s_and_b32 s17, s12, 1
    s_lshl_b32 s17, s17, 2
    s_add_u32 s52, s52, s17
    s_add_u32 s52, s52, 13631488
    s_mov_b32 s42, 0
    s_mov_b32 s22, 0
    v_add_u32 v3, 0, v6
    v_add_u32 v4, 0, v7
    v_add_u32 v160, 0, v161
    v_add_u32 v5, 0, v8
    ds_read2st64_b64 v[36:39], v3 offset0:0 offset1:1
    ds_read_b32 v40, v5 offset:0
    v_mov_b32 v156, s29
    s_waitcnt lgkmcnt(0)
    v_mfma_f32_32x32x16_bf16 v[68:83], v[36:39], v[28:31], 0
    v_mfma_f32_32x32x8_bf16 v[68:83], v[40:41], v[32:33], v[68:83]
    ds_read2st64_b64 v[36:39], v3 offset0:0 offset1:1
    ds_read_b32 v40, v5 offset:0
    ds_read2st64_b64 v[44:47], v3 offset0:2 offset1:3
    ds_read_b32 v48, v5 offset:128
    ds_read_b128 v[52:55], v4 offset:0
    ds_read_b128 v[56:59], v160 offset:0
    v_mov_b32 v108, 0
    v_mov_b32 v109, 0
    v_mov_b32 v110, 0
    v_mov_b32 v111, 0
    v_mov_b32 v112, 0
    v_mov_b32 v113, 0
    v_mov_b32 v114, 0
    v_mov_b32 v115, 0
    v_mov_b32 v116, 0
    v_mov_b32 v117, 0
    v_mov_b32 v118, 0
    v_mov_b32 v119, 0
    v_mov_b32 v120, 0
    v_mov_b32 v121, 0
    v_mov_b32 v122, 0
    v_mov_b32 v123, 0
    v_mov_b32 v104, 0
    v_mov_b32 v105, 0
    v_mov_b32 v106, 0
    v_mov_b32 v107, 0
    v_mov_b32 v60, 0
    v_mov_b32 v61, 0
    v_mov_b32 v62, 0
    v_mov_b32 v63, 0
    v_mov_b32 v64, 0
    v_mov_b32 v65, 0
    v_mov_b32 v66, 0
    v_mov_b32 v67, 0
    v_max3_f32 v156, v68, v69, v156
    v_max3_f32 v156, v70, v71, v156
    v_max3_f32 v156, v72, v73, v156
    v_max3_f32 v156, v74, v75, v156
    v_max3_f32 v156, v76, v77, v156
    v_max3_f32 v156, v78, v79, v156
    v_max3_f32 v156, v80, v81, v156
    v_max3_f32 v156, v82, v83, v156
    v_mov_b32 v10, v156
    s_nop 1
    v_permlane32_swap_b32 v156, v10
    v_max_f32 v156, v156, v10
    v_sub_f32 v10, 0, v156
    v_cvt_pk_bf16_f32 v11, v10, 1.0
    v_lshlrev_b32 v12, 16, v11
    v_sub_f32 v12, v10, v12
    v_cvt_pk_bf16_f32 v12, v12, 0
    v_cmp_gt_u32 vcc, 32, v1
    s_nop 1
    v_cndmask_b32 v33, v12, v11, vcc
    s_waitcnt lgkmcnt(4)
    v_mfma_f32_32x32x16_bf16 v[68:83], v[36:39], v[28:31], 0
    v_mfma_f32_32x32x8_bf16 v[68:83], v[40:41], v[32:33], v[68:83]
    s_mov_b32 s20, 0
    s_mov_b32 s38, 0
    s_lshr_b32 s46, s14, 2
    s_nop 7
.p2align 3
k2_attn_kernel_bloop0:
    s_lshl_b32 s17, s20, 2
    s_add_u32 s17, s17, 13
    s_lshr_b32 s17, s17, 3
    s_cmp_ge_u32 s42, s17
    s_cbranch_scc1 k2_attn_kernel_ng_okl
k2_attn_kernel_ngl:
    ds_read_b64 v[10:11], v157
    s_waitcnt lgkmcnt(0)
    v_min_u32 v10, v10, v11
    s_nop 0
    v_readfirstlane_b32 s42, v10
    s_nop 1
    s_cmp_ge_u32 s42, s17
    s_cbranch_scc1 k2_attn_kernel_ng_okl
    s_sleep 1
    s_branch k2_attn_kernel_ngl
k2_attn_kernel_ng_okl:
    v_exp_f32 v68, v68
    v_exp_f32 v69, v69
    v_mfma_f32_32x32x16_bf16 v[108:123], v[64:67], v[104:107], v[108:123]
    v_exp_f32 v70, v70
    v_exp_f32 v71, v71
    v_exp_f32 v72, v72
    s_waitcnt lgkmcnt(2)
    v_mfma_f32_32x32x16_bf16 v[84:99], v[44:47], v[28:31], 0
    ds_read2st64_b64 v[36:39], v3 offset0:4 offset1:5
    ds_read_b32 v40, v5 offset:256
    v_exp_f32 v73, v73
    v_exp_f32 v74, v74
    v_exp_f32 v75, v75
    v_exp_f32 v76, v76
    v_cvt_pk_bf16_f32 v100, v68, v69
    v_cvt_pk_bf16_f32 v101, v70, v71
    v_cvt_pk_bf16_f32 v102, v72, v73
    v_cvt_pk_bf16_f32 v103, v74, v75
    v_mfma_f32_32x32x8_bf16 v[84:99], v[48:49], v[32:33], v[84:99]
    ds_read_b128 v[60:63], v4 offset:1280
    ds_read_b128 v[64:67], v160 offset:1280
    v_exp_f32 v77, v77
    v_exp_f32 v78, v78
    v_exp_f32 v79, v79
    v_exp_f32 v80, v80
    v_exp_f32 v81, v81
    s_waitcnt lgkmcnt(4)
    v_mfma_f32_32x32x16_bf16 v[108:123], v[52:55], v[100:103], v[108:123]
    v_exp_f32 v82, v82
    v_exp_f32 v83, v83
    v_cvt_pk_bf16_f32 v104, v76, v77
    v_cvt_pk_bf16_f32 v105, v78, v79
    v_cvt_pk_bf16_f32 v106, v80, v81
    v_cvt_pk_bf16_f32 v107, v82, v83
    v_exp_f32 v84, v84
    v_exp_f32 v85, v85
    v_mfma_f32_32x32x16_bf16 v[108:123], v[56:59], v[104:107], v[108:123]
    v_exp_f32 v86, v86
    v_exp_f32 v87, v87
    v_exp_f32 v88, v88
    s_waitcnt lgkmcnt(2)
    v_mfma_f32_32x32x16_bf16 v[68:83], v[36:39], v[28:31], 0
    ds_read2st64_b64 v[44:47], v3 offset0:6 offset1:7
    ds_read_b32 v48, v5 offset:384
    v_exp_f32 v89, v89
    v_exp_f32 v90, v90
    v_exp_f32 v91, v91
    v_exp_f32 v92, v92
    v_cvt_pk_bf16_f32 v100, v84, v85
    v_cvt_pk_bf16_f32 v101, v86, v87
    v_cvt_pk_bf16_f32 v102, v88, v89
    v_cvt_pk_bf16_f32 v103, v90, v91
    v_mfma_f32_32x32x8_bf16 v[68:83], v[40:41], v[32:33], v[68:83]
    ds_read_b128 v[52:55], v4 offset:2560
    ds_read_b128 v[56:59], v160 offset:2560
    v_exp_f32 v93, v93
    v_exp_f32 v94, v94
    v_exp_f32 v95, v95
    v_exp_f32 v96, v96
    v_exp_f32 v97, v97
    s_waitcnt lgkmcnt(4)
    v_mfma_f32_32x32x16_bf16 v[108:123], v[60:63], v[100:103], v[108:123]
    v_exp_f32 v98, v98
    v_exp_f32 v99, v99
    v_cvt_pk_bf16_f32 v104, v92, v93
    v_cvt_pk_bf16_f32 v105, v94, v95
    v_cvt_pk_bf16_f32 v106, v96, v97
    v_cvt_pk_bf16_f32 v107, v98, v99
    v_exp_f32 v68, v68
    v_exp_f32 v69, v69
    v_mfma_f32_32x32x16_bf16 v[108:123], v[64:67], v[104:107], v[108:123]
    v_exp_f32 v70, v70
    v_exp_f32 v71, v71
    v_exp_f32 v72, v72
    s_waitcnt lgkmcnt(2)
    v_mfma_f32_32x32x16_bf16 v[84:99], v[44:47], v[28:31], 0
    ds_read2st64_b64 v[36:39], v3 offset0:8 offset1:9
    ds_read_b32 v40, v5 offset:512
    v_exp_f32 v73, v73
    v_exp_f32 v74, v74
    v_exp_f32 v75, v75
    v_exp_f32 v76, v76
    v_cvt_pk_bf16_f32 v100, v68, v69
    v_cvt_pk_bf16_f32 v101, v70, v71
    v_cvt_pk_bf16_f32 v102, v72, v73
    v_cvt_pk_bf16_f32 v103, v74, v75
    v_mfma_f32_32x32x8_bf16 v[84:99], v[48:49], v[32:33], v[84:99]
    ds_read_b128 v[60:63], v4 offset:3840
    ds_read_b128 v[64:67], v160 offset:3840
    v_exp_f32 v77, v77
    v_exp_f32 v78, v78
    v_exp_f32 v79, v79
    v_exp_f32 v80, v80
    v_exp_f32 v81, v81
    s_waitcnt lgkmcnt(4)
    v_mfma_f32_32x32x16_bf16 v[108:123], v[52:55], v[100:103], v[108:123]
    v_exp_f32 v82, v82
    v_exp_f32 v83, v83
    v_cvt_pk_bf16_f32 v104, v76, v77
    v_cvt_pk_bf16_f32 v105, v78, v79
    v_cvt_pk_bf16_f32 v106, v80, v81
    v_cvt_pk_bf16_f32 v107, v82, v83
    v_exp_f32 v84, v84
    v_exp_f32 v85, v85
    v_mfma_f32_32x32x16_bf16 v[108:123], v[56:59], v[104:107], v[108:123]
    v_exp_f32 v86, v86
    v_exp_f32 v87, v87
    v_exp_f32 v88, v88
    s_waitcnt lgkmcnt(2)
    v_mfma_f32_32x32x16_bf16 v[68:83], v[36:39], v[28:31], 0
    ds_read2st64_b64 v[44:47], v3 offset0:10 offset1:11
    ds_read_b32 v48, v5 offset:640
    v_exp_f32 v89, v89
    v_exp_f32 v90, v90
    v_exp_f32 v91, v91
    v_exp_f32 v92, v92
    v_cvt_pk_bf16_f32 v100, v84, v85
    v_cvt_pk_bf16_f32 v101, v86, v87
    v_cvt_pk_bf16_f32 v102, v88, v89
    v_cvt_pk_bf16_f32 v103, v90, v91
    v_mfma_f32_32x32x8_bf16 v[68:83], v[40:41], v[32:33], v[68:83]
    ds_read_b128 v[52:55], v4 offset:5120
    ds_read_b128 v[56:59], v160 offset:5120
    v_exp_f32 v93, v93
    v_exp_f32 v94, v94
    v_exp_f32 v95, v95
    v_exp_f32 v96, v96
    v_exp_f32 v97, v97
    s_waitcnt lgkmcnt(4)
    v_mfma_f32_32x32x16_bf16 v[108:123], v[60:63], v[100:103], v[108:123]
    v_exp_f32 v98, v98
    v_exp_f32 v99, v99
    v_cvt_pk_bf16_f32 v104, v92, v93
    v_cvt_pk_bf16_f32 v105, v94, v95
    v_cvt_pk_bf16_f32 v106, v96, v97
    v_cvt_pk_bf16_f32 v107, v98, v99
    v_add_u32 v3, 4096, v3
    v_add_u32 v4, 5120, v4
    v_add_u32 v160, 5120, v160
    v_add_u32 v5, 512, v5
    s_add_u32 s20, s20, 1
    s_cmp_lt_u32 s20, 4
    s_cbranch_scc1 k2_attn_kernel_bloop0
    v_mov_b32 v10, 1
    s_mov_b64 exec, 1
    ds_add_u32 v157, v10 offset:8
    s_mov_b64 exec, -1
    s_cmp_ge_u32 s42, 8
    s_cbranch_scc1 k2_attn_kernel_ng_okm
k2_attn_kernel_ngm:
    ds_read_b64 v[10:11], v157
    s_waitcnt lgkmcnt(0)
    v_min_u32 v10, v10, v11
    s_nop 0
    v_readfirstlane_b32 s42, v10
    s_nop 1
    s_cmp_ge_u32 s42, 8
    s_cbranch_scc1 k2_attn_kernel_ng_okm
    s_sleep 1
    s_branch k2_attn_kernel_ngm
k2_attn_kernel_ng_okm:
.p2align 3
k2_attn_kernel_bloop:
    v_exp_f32 v68, v68
    v_exp_f32 v69, v69
    v_mfma_f32_32x32x16_bf16 v[108:123], v[64:67], v[104:107], v[108:123]
    v_exp_f32 v70, v70
    v_exp_f32 v71, v71
    v_exp_f32 v72, v72
    s_waitcnt lgkmcnt(2)
    v_mfma_f32_32x32x16_bf16 v[84:99], v[44:47], v[28:31], 0
    ds_read2st64_b64 v[36:39], v3 offset0:4 offset1:5
    ds_read_b32 v40, v5 offset:256
    v_exp_f32 v73, v73
    v_exp_f32 v74, v74
    v_exp_f32 v75, v75
    v_exp_f32 v76, v76
    v_cvt_pk_bf16_f32 v100, v68, v69
    v_cvt_pk_bf16_f32 v101, v70, v71
    v_cvt_pk_bf16_f32 v102, v72, v73
    v_cvt_pk_bf16_f32 v103, v74, v75
    v_mfma_f32_32x32x8_bf16 v[84:99], v[48:49], v[32:33], v[84:99]
    ds_read_b128 v[60:63], v4 offset:1280
    ds_read_b128 v[64:67], v160 offset:1280
    v_exp_f32 v77, v77
    v_exp_f32 v78, v78
    v_exp_f32 v79, v79
    v_exp_f32 v80, v80
    v_exp_f32 v81, v81
    s_waitcnt lgkmcnt(4)
    v_mfma_f32_32x32x16_bf16 v[108:123], v[52:55], v[100:103], v[108:123]
    v_exp_f32 v82, v82
    v_exp_f32 v83, v83
    v_cvt_pk_bf16_f32 v104, v76, v77
    v_cvt_pk_bf16_f32 v105, v78, v79
    v_cvt_pk_bf16_f32 v106, v80, v81
    v_cvt_pk_bf16_f32 v107, v82, v83
    v_exp_f32 v84, v84
    v_exp_f32 v85, v85
    v_mfma_f32_32x32x16_bf16 v[108:123], v[56:59], v[104:107], v[108:123]
    v_exp_f32 v86, v86
    v_exp_f32 v87, v87
    v_exp_f32 v88, v88
    s_waitcnt lgkmcnt(2)
    v_mfma_f32_32x32x16_bf16 v[68:83], v[36:39], v[28:31], 0
    ds_read2st64_b64 v[44:47], v3 offset0:6 offset1:7
    ds_read_b32 v48, v5 offset:384
    v_exp_f32 v89, v89
    v_exp_f32 v90, v90
    v_exp_f32 v91, v91
    v_exp_f32 v92, v92
    v_cvt_pk_bf16_f32 v100, v84, v85
    v_cvt_pk_bf16_f32 v101, v86, v87
    v_cvt_pk_bf16_f32 v102, v88, v89
    v_cvt_pk_bf16_f32 v103, v90, v91
    v_mfma_f32_32x32x8_bf16 v[68:83], v[40:41], v[32:33], v[68:83]
    ds_read_b128 v[52:55], v4 offset:2560
    ds_read_b128 v[56:59], v160 offset:2560
    v_exp_f32 v93, v93
    v_exp_f32 v94, v94
    v_exp_f32 v95, v95
    v_exp_f32 v96, v96
    v_exp_f32 v97, v97
    s_waitcnt lgkmcnt(4)
    v_mfma_f32_32x32x16_bf16 v[108:123], v[60:63], v[100:103], v[108:123]
    v_exp_f32 v98, v98
    v_exp_f32 v99, v99
    v_cvt_pk_bf16_f32 v104, v92, v93
    v_cvt_pk_bf16_f32 v105, v94, v95
    v_cvt_pk_bf16_f32 v106, v96, v97
    v_cvt_pk_bf16_f32 v107, v98, v99
    v_exp_f32 v68, v68
    v_exp_f32 v69, v69
    v_mfma_f32_32x32x16_bf16 v[108:123], v[64:67], v[104:107], v[108:123]
    v_exp_f32 v70, v70
    v_exp_f32 v71, v71
    v_exp_f32 v72, v72
    s_waitcnt lgkmcnt(2)
    v_mfma_f32_32x32x16_bf16 v[84:99], v[44:47], v[28:31], 0
    ds_read2st64_b64 v[36:39], v3 offset0:8 offset1:9
    ds_read_b32 v40, v5 offset:512
    v_exp_f32 v73, v73
    v_exp_f32 v74, v74
    v_exp_f32 v75, v75
    v_exp_f32 v76, v76
    v_cvt_pk_bf16_f32 v100, v68, v69
    v_cvt_pk_bf16_f32 v101, v70, v71
    v_cvt_pk_bf16_f32 v102, v72, v73
    v_cvt_pk_bf16_f32 v103, v74, v75
    v_mfma_f32_32x32x8_bf16 v[84:99], v[48:49], v[32:33], v[84:99]
    ds_read_b128 v[60:63], v4 offset:3840
    ds_read_b128 v[64:67], v160 offset:3840
    v_exp_f32 v77, v77
    v_exp_f32 v78, v78
    v_exp_f32 v79, v79
    v_exp_f32 v80, v80
    v_exp_f32 v81, v81
    s_waitcnt lgkmcnt(4)
    v_mfma_f32_32x32x16_bf16 v[108:123], v[52:55], v[100:103], v[108:123]
    v_exp_f32 v82, v82
    v_exp_f32 v83, v83
    v_cvt_pk_bf16_f32 v104, v76, v77
    v_cvt_pk_bf16_f32 v105, v78, v79
    v_cvt_pk_bf16_f32 v106, v80, v81
    v_cvt_pk_bf16_f32 v107, v82, v83
    v_exp_f32 v84, v84
    v_exp_f32 v85, v85
    v_mfma_f32_32x32x16_bf16 v[108:123], v[56:59], v[104:107], v[108:123]
    v_exp_f32 v86, v86
    v_exp_f32 v87, v87
    v_exp_f32 v88, v88
    s_waitcnt lgkmcnt(2)
    v_mfma_f32_32x32x16_bf16 v[68:83], v[36:39], v[28:31], 0
    ds_read2st64_b64 v[44:47], v3 offset0:10 offset1:11
    ds_read_b32 v48, v5 offset:640
    v_exp_f32 v89, v89
    v_exp_f32 v90, v90
    v_exp_f32 v91, v91
    v_exp_f32 v92, v92
    v_cvt_pk_bf16_f32 v100, v84, v85
    v_cvt_pk_bf16_f32 v101, v86, v87
    v_cvt_pk_bf16_f32 v102, v88, v89
    v_cvt_pk_bf16_f32 v103, v90, v91
    v_mfma_f32_32x32x8_bf16 v[68:83], v[40:41], v[32:33], v[68:83]
    ds_read_b128 v[52:55], v4 offset:5120
    ds_read_b128 v[56:59], v160 offset:5120
    v_exp_f32 v93, v93
    v_exp_f32 v94, v94
    v_exp_f32 v95, v95
    v_exp_f32 v96, v96
    v_exp_f32 v97, v97
    s_waitcnt lgkmcnt(4)
    v_mfma_f32_32x32x16_bf16 v[108:123], v[60:63], v[100:103], v[108:123]
    v_exp_f32 v98, v98
    v_exp_f32 v99, v99
    v_cvt_pk_bf16_f32 v104, v92, v93
    v_cvt_pk_bf16_f32 v105, v94, v95
    v_cvt_pk_bf16_f32 v106, v96, v97
    v_cvt_pk_bf16_f32 v107, v98, v99
    v_exp_f32 v68, v68
    v_exp_f32 v69, v69
    v_mfma_f32_32x32x16_bf16 v[108:123], v[64:67], v[104:107], v[108:123]
    v_exp_f32 v70, v70
    v_exp_f32 v71, v71
    v_exp_f32 v72, v72
    s_waitcnt lgkmcnt(2)
    v_mfma_f32_32x32x16_bf16 v[84:99], v[44:47], v[28:31], 0
    ds_read2st64_b64 v[36:39], v3 offset0:12 offset1:13
    ds_read_b32 v40, v5 offset:768
    v_exp_f32 v73, v73
    v_exp_f32 v74, v74
    v_exp_f32 v75, v75
    v_exp_f32 v76, v76
    v_cvt_pk_bf16_f32 v100, v68, v69
    v_cvt_pk_bf16_f32 v101, v70, v71
    v_cvt_pk_bf16_f32 v102, v72, v73
    v_cvt_pk_bf16_f32 v103, v74, v75
    v_mfma_f32_32x32x8_bf16 v[84:99], v[48:49], v[32:33], v[84:99]
    ds_read_b128 v[60:63], v4 offset:6400
    ds_read_b128 v[64:67], v160 offset:6400
    v_exp_f32 v77, v77
    v_exp_f32 v78, v78
    v_exp_f32 v79, v79
    v_exp_f32 v80, v80
    v_exp_f32 v81, v81
    s_waitcnt lgkmcnt(4)
    v_mfma_f32_32x32x16_bf16 v[108:123], v[52:55], v[100:103], v[108:123]
    v_exp_f32 v82, v82
    v_exp_f32 v83, v83
    v_cvt_pk_bf16_f32 v104, v76, v77
    v_cvt_pk_bf16_f32 v105, v78, v79
    v_cvt_pk_bf16_f32 v106, v80, v81
    v_cvt_pk_bf16_f32 v107, v82, v83
    v_exp_f32 v84, v84
    v_exp_f32 v85, v85
    v_mfma_f32_32x32x16_bf16 v[108:123], v[56:59], v[104:107], v[108:123]
    v_exp_f32 v86, v86
    v_exp_f32 v87, v87
    v_exp_f32 v88, v88
    s_waitcnt lgkmcnt(2)
    v_mfma_f32_32x32x16_bf16 v[68:83], v[36:39], v[28:31], 0
    ds_read2st64_b64 v[44:47], v3 offset0:14 offset1:15
    ds_read_b32 v48, v5 offset:896
    v_exp_f32 v89, v89
    v_exp_f32 v90, v90
    v_exp_f32 v91, v91
    v_exp_f32 v92, v92
    v_cvt_pk_bf16_f32 v100, v84, v85
    v_cvt_pk_bf16_f32 v101, v86, v87
    v_cvt_pk_bf16_f32 v102, v88, v89
    v_cvt_pk_bf16_f32 v103, v90, v91
    v_mfma_f32_32x32x8_bf16 v[68:83], v[40:41], v[32:33], v[68:83]
    ds_read_b128 v[52:55], v4 offset:7680
    ds_read_b128 v[56:59], v160 offset:7680
    v_exp_f32 v93, v93
    v_exp_f32 v94, v94
    v_exp_f32 v95, v95
    v_exp_f32 v96, v96
    v_exp_f32 v97, v97
    s_waitcnt lgkmcnt(4)
    v_mfma_f32_32x32x16_bf16 v[108:123], v[60:63], v[100:103], v[108:123]
    v_exp_f32 v98, v98
    v_exp_f32 v99, v99
    v_cvt_pk_bf16_f32 v104, v92, v93
    v_cvt_pk_bf16_f32 v105, v94, v95
    v_cvt_pk_bf16_f32 v106, v96, v97
    v_cvt_pk_bf16_f32 v107, v98, v99
    v_exp_f32 v68, v68
    v_exp_f32 v69, v69
    v_mfma_f32_32x32x16_bf16 v[108:123], v[64:67], v[104:107], v[108:123]
    v_exp_f32 v70, v70
    v_exp_f32 v71, v71
    v_exp_f32 v72, v72
    s_waitcnt lgkmcnt(2)
    v_mfma_f32_32x32x16_bf16 v[84:99], v[44:47], v[28:31], 0
    ds_read2st64_b64 v[36:39], v3 offset0:16 offset1:17
    ds_read_b32 v40, v5 offset:1024
    v_exp_f32 v73, v73
    v_exp_f32 v74, v74
    v_exp_f32 v75, v75
    v_exp_f32 v76, v76
    v_cvt_pk_bf16_f32 v100, v68, v69
    v_cvt_pk_bf16_f32 v101, v70, v71
    v_cvt_pk_bf16_f32 v102, v72, v73
    v_cvt_pk_bf16_f32 v103, v74, v75
    v_mfma_f32_32x32x8_bf16 v[84:99], v[48:49], v[32:33], v[84:99]
    ds_read_b128 v[60:63], v4 offset:8960
    ds_read_b128 v[64:67], v160 offset:8960
    v_exp_f32 v77, v77
    v_exp_f32 v78, v78
    v_exp_f32 v79, v79
    v_exp_f32 v80, v80
    v_exp_f32 v81, v81
    s_waitcnt lgkmcnt(4)
    v_mfma_f32_32x32x16_bf16 v[108:123], v[52:55], v[100:103], v[108:123]
    v_exp_f32 v82, v82
    v_exp_f32 v83, v83
    v_cvt_pk_bf16_f32 v104, v76, v77
    v_cvt_pk_bf16_f32 v105, v78, v79
    v_cvt_pk_bf16_f32 v106, v80, v81
    v_cvt_pk_bf16_f32 v107, v82, v83
    v_exp_f32 v84, v84
    v_exp_f32 v85, v85
    v_mfma_f32_32x32x16_bf16 v[108:123], v[56:59], v[104:107], v[108:123]
    v_exp_f32 v86, v86
    v_exp_f32 v87, v87
    v_exp_f32 v88, v88
    s_waitcnt lgkmcnt(2)
    v_mfma_f32_32x32x16_bf16 v[68:83], v[36:39], v[28:31], 0
    ds_read2st64_b64 v[44:47], v3 offset0:18 offset1:19
    ds_read_b32 v48, v5 offset:1152
    v_exp_f32 v89, v89
    v_exp_f32 v90, v90
    v_exp_f32 v91, v91
    v_exp_f32 v92, v92
    v_cvt_pk_bf16_f32 v100, v84, v85
    v_cvt_pk_bf16_f32 v101, v86, v87
    v_cvt_pk_bf16_f32 v102, v88, v89
    v_cvt_pk_bf16_f32 v103, v90, v91
    v_mfma_f32_32x32x8_bf16 v[68:83], v[40:41], v[32:33], v[68:83]
    ds_read_b128 v[52:55], v4 offset:10240
    ds_read_b128 v[56:59], v160 offset:10240
    v_exp_f32 v93, v93
    v_exp_f32 v94, v94
    v_exp_f32 v95, v95
    v_exp_f32 v96, v96
    v_exp_f32 v97, v97
    s_waitcnt lgkmcnt(4)
    v_mfma_f32_32x32x16_bf16 v[108:123], v[60:63], v[100:103], v[108:123]
    v_exp_f32 v98, v98
    v_exp_f32 v99, v99
    v_cvt_pk_bf16_f32 v104, v92, v93
    v_cvt_pk_bf16_f32 v105, v94, v95
    v_cvt_pk_bf16_f32 v106, v96, v97
    v_cvt_pk_bf16_f32 v107, v98, v99
    v_add_u32 v3, 8192, v3
    v_add_u32 v4, 10240, v4
    v_add_u32 v160, 10240, v160
    v_add_u32 v5, 1024, v5
    s_add_u32 s20, s20, 2
    s_cmp_lt_u32 s20, 16
    s_cbranch_scc1 k2_attn_kernel_bloop
    s_setprio 0
    s_nop 1
    v_mfma_f32_32x32x16_bf16 v[108:123], v[64:67], v[104:107], v[108:123]
    s_waitcnt vmcnt(0)
    v_mov_b32 v10, 1
    s_mov_b64 exec, 1
    ds_add_rtn_u32 v11, v157, v10 offset:16
    s_mov_b64 exec, -1
    s_waitcnt lgkmcnt(0)
    v_readfirstlane_b32 s50, v11
    s_nop 1
    s_cmp_ge_u32 s50, 8
    s_cbranch_scc1 k2_attn_kernel_claim0
    s_lshl_b32 s51, s13, 3
    s_add_u32 s51, s51, s50
    s_lshl_b32 s16, s12, 16
    s_lshl_b32 s17, s51, 10
    s_add_u32 s16, s16, s17
    buffer_load_dwordx2 v[20:21], v34, s[8:11], s16 offen
    buffer_load_dwordx2 v[22:23], v34, s[8:11], s16 offen offset:512
    s_lshl_b32 s17, s51, 8
    s_add_u32 s17, s17, s52
    v_and_b32 v10, 31, v1
    v_lshlrev_b32 v11, 3, v10
    buffer_load_dword v24, v11, s[8:11], s17 offen
    v_lshlrev_b32 v12, 2, v10
    s_lshl_b32 s16, s51, 7
    s_add_u32 s16, s16, 14680064
    buffer_load_dword v26, v12, s[8:11], s16 offen
k2_attn_kernel_claim0:
    s_nop 12
    v_mov_b32 v10, 1904214016
    v_cmp_nlt_f32 vcc, v118, v10
    v_max3_f32 v11, |v108|, |v109|, |v110|
    v_max3_f32 v12, |v111|, |v112|, |v113|
    v_max3_f32 v13, |v114|, |v115|, |v116|
    v_max3_f32 v11, v11, v12, v13
    v_max3_f32 v11, v11, |v117|, |v117|
    s_bfm_b64 s[32:33], 32, 0
    s_and_b64 s[32:33], vcc, s[32:33]
    v_mov_b32 v10, 0x7f800000
    v_cmp_nlt_f32 vcc, v11, v10
    s_nop 1
    s_or_b64 vcc, vcc, s[32:33]
    s_cbranch_scc0 k2_attn_kernel_bfin
    s_add_u32 s43, s24, 2097152
    s_add_u32 s44, s25, 2621440
    s_add_u32 s45, s26, 262144
    v_mov_b32 v10, 1065353216
    v_cmp_gt_u32 vcc, 32, v1
    s_nop 1
    v_cndmask_b32 v33, 0, v10, vcc
    v_mov_b32 v156, s29
    s_mov_b32 s20, 0
k2_attn_kernel_bx1:
    s_lshl_b32 s16, s20, 10
    s_add_u32 s16, s16, s43
    buffer_load_dwordx2 v[36:37], v34, s[8:11], s16 offen
    buffer_load_dwordx2 v[38:39], v34, s[8:11], s16 offen offset:512
    s_lshl_b32 s16, s20, 8
    s_add_u32 s16, s16, s45
    buffer_load_dword v40, v159, s[8:11], s16 offen
    s_waitcnt vmcnt(0)
    v_mfma_f32_32x32x16_bf16 v[68:83], v[36:39], v[28:31], 0
    v_mfma_f32_32x32x8_bf16 v[68:83], v[40:41], v[32:33], v[68:83]
    s_nop 11
    v_max3_f32 v156, v68, v69, v156
    v_max3_f32 v156, v70, v71, v156
    v_max3_f32 v156, v72, v73, v156
    v_max3_f32 v156, v74, v75, v156
    v_max3_f32 v156, v76, v77, v156
    v_max3_f32 v156, v78, v79, v156
    v_max3_f32 v156, v80, v81, v156
    v_max3_f32 v156, v82, v83, v156
    s_add_u32 s20, s20, 1
    s_cmp_lt_u32 s20, 64
    s_cbranch_scc1 k2_attn_kernel_bx1
    v_mov_b32 v10, v156
    s_nop 1
    v_permlane32_swap_b32 v156, v10
    v_max_f32 v156, v156, v10
    v_sub_f32 v10, 0, v156
    v_cvt_pk_bf16_f32 v11, v10, 1.0
    v_lshlrev_b32 v12, 16, v11
    v_sub_f32 v12, v10, v12
    v_cvt_pk_bf16_f32 v12, v12, 0
    v_cmp_gt_u32 vcc, 32, v1
    s_nop 1
    v_cndmask_b32 v33, v12, v11, vcc
    v_mov_b32 v108, 0
    v_mov_b32 v109, 0
    v_mov_b32 v110, 0
    v_mov_b32 v111, 0
    v_mov_b32 v112, 0
    v_mov_b32 v113, 0
    v_mov_b32 v114, 0
    v_mov_b32 v115, 0
    v_mov_b32 v116, 0
    v_mov_b32 v117, 0
    v_mov_b32 v118, 0
    v_mov_b32 v119, 0
    v_mov_b32 v120, 0
    v_mov_b32 v121, 0
    v_mov_b32 v122, 0
    v_mov_b32 v123, 0
    s_mov_b32 s20, 0
k2_attn_kernel_bx2:
    s_lshl_b32 s16, s20, 10
    s_add_u32 s16, s16, s43
    buffer_load_dwordx2 v[36:37], v34, s[8:11], s16 offen
    buffer_load_dwordx2 v[38:39], v34, s[8:11], s16 offen offset:512
    s_lshl_b32 s16, s20, 8
    s_add_u32 s16, s16, s45
    buffer_load_dword v40, v159, s[8:11], s16 offen
    s_mul_i32 s16, s20, 1280
    s_add_u32 s16, s16, s44
    buffer_load_dwordx4 v[52:55], v158, s[8:11], s16 offen
    buffer_load_dwordx4 v[56:59], v162, s[8:11], s16 offen
    s_waitcnt vmcnt(0)
    v_mfma_f32_32x32x16_bf16 v[68:83], v[36:39], v[28:31], 0
    v_mfma_f32_32x32x8_bf16 v[68:83], v[40:41], v[32:33], v[68:83]
    s_nop 11
    v_exp_f32 v68, v68
    v_exp_f32 v69, v69
    v_exp_f32 v70, v70
    v_exp_f32 v71, v71
    v_exp_f32 v72, v72
    v_exp_f32 v73, v73
    v_exp_f32 v74, v74
    v_exp_f32 v75, v75
    v_exp_f32 v76, v76
    v_exp_f32 v77, v77
    v_exp_f32 v78, v78
    v_exp_f32 v79, v79
    v_exp_f32 v80, v80
    v_exp_f32 v81, v81
    v_exp_f32 v82, v82
    v_exp_f32 v83, v83
    v_cvt_pk_bf16_f32 v100, v68, v69
    v_cvt_pk_bf16_f32 v101, v70, v71
    v_cvt_pk_bf16_f32 v102, v72, v73
    v_cvt_pk_bf16_f32 v103, v74, v75
    v_cvt_pk_bf16_f32 v104, v76, v77
    v_cvt_pk_bf16_f32 v105, v78, v79
    v_cvt_pk_bf16_f32 v106, v80, v81
    v_cvt_pk_bf16_f32 v107, v82, v83
    v_mfma_f32_32x32x16_bf16 v[108:123], v[52:55], v[100:103], v[108:123]
    s_nop 0
    v_mfma_f32_32x32x16_bf16 v[108:123], v[56:59], v[104:107], v[108:123]
    s_add_u32 s20, s20, 1
    s_cmp_lt_u32 s20, 64
    s_cbranch_scc1 k2_attn_kernel_bx2
    s_nop 12
k2_attn_kernel_bfin:
    v_mov_b32 v10, v118
    v_mov_b32 v11, v118
    s_nop 1
    v_permlane32_swap_b32 v10, v11
    v_rcp_f32 v12, v10
    v_sub_f32 v13, 1.0, v9
    v_mul_f32 v12, v12, v13
    v_mul_f32 v108, v108, v12
    v_mul_f32 v109, v109, v12
    v_mul_f32 v110, v110, v12
    v_mul_f32 v111, v111, v12
    v_mul_f32 v112, v112, v12
    v_mul_f32 v113, v113, v12
    v_mul_f32 v114, v114, v12
    v_mul_f32 v115, v115, v12
    v_mul_f32 v116, v116, v12
    v_mul_f32 v117, v117, v12
    v_cvt_pk_bf16_f32 v100, v108, v109
    v_cvt_pk_bf16_f32 v101, v110, v111
    v_cvt_pk_bf16_f32 v102, v112, v113
    v_cvt_pk_bf16_f32 v103, v114, v115
    v_cvt_pk_bf16_f32 v104, v116, v117
    s_lshl_b32 s16, s15, 5
    s_add_u32 s16, s16, s12
    s_lshl_b32 s17, s16, 10
    s_add_u32 s17, s17, 18874368
    buffer_store_dwordx4 v[100:103], v2, s[8:11], s17 offen sc1
    s_lshl_b32 s17, s16, 7
    s_add_u32 s17, s17, 21233664
    v_lshlrev_b32 v14, 2, v1
    s_bfm_b64 exec, 32, 0
    buffer_store_dword v104, v14, s[8:11], s17 offen sc1
    s_mov_b64 exec, -1
    s_cmp_ge_u32 s50, 8
    s_cbranch_scc1 k2_attn_kernel_done
k2_attn_kernel_polla:
    ds_read_b32 v10, v157 offset:12
    s_waitcnt lgkmcnt(0)
    v_readfirstlane_b32 s16, v10
    s_nop 1
    s_cmp_ge_u32 s16, 2
    s_cbranch_scc1 k2_attn_kernel_polloka
    s_sleep 1
    s_branch k2_attn_kernel_polla
k2_attn_kernel_polloka:
k2_attn_kernel_aitem:
    s_mov_b32 s15, s51
    s_mov_b32 s53, s50
    s_waitcnt vmcnt(2)
    v_mov_b32 v27, v26
    v_cmp_gt_u32 vcc, 32, v1
    v_mov_b32 v16, 1065353216
    s_nop 0
    v_cndmask_b32 v24, 0, v24, vcc
    v_cndmask_b32 v25, 0, v16, vcc
    s_mov_b32 s36, 0x3f80
    s_mov_b32 s37, 4048109440
    s_lshl_b32 s16, s53, 10
    v_add_u32 v3, s16, v6
    s_mul_i32 s16, s53, 1280
    v_add_u32 v4, s16, v7
    v_add_u32 v160, s16, v161
    s_lshl_b32 s16, s53, 7
    v_add_u32 v5, s16, v8
    v_mov_b32 v156, s29
    s_cmp_eq_u32 s15, 0
    s_cbranch_scc1 k2_attn_kernel_aref0
    ds_read2st64_b64 v[36:39], v3 offset0:14 offset1:15
    ds_read_b32 v40, v5 offset:896
    s_waitcnt lgkmcnt(0)
    v_mfma_f32_32x32x16_bf16 v[68:83], v[36:39], v[20:23], 0
    v_mfma_f32_32x32x8_bf16 v[68:83], v[40:41], v[24:25], v[68:83]
    s_branch k2_attn_kernel_aref1
k2_attn_kernel_aref0:
    ds_read2st64_b64 v[36:39], v3 offset0:16 offset1:17
    ds_read_b32 v40, v5 offset:1024
    s_waitcnt lgkmcnt(0)
    v_mfma_f32_32x32x16_bf16 v[68:83], v[36:39], v[20:23], v[140:155]
    v_mfma_f32_32x32x8_bf16 v[68:83], v[40:41], v[24:25], v[68:83]
k2_attn_kernel_aref1:
    ds_read2st64_b64 v[36:39], v3 offset0:0 offset1:1
    ds_read_b32 v40, v5 offset:0
    ds_read2st64_b64 v[44:47], v3 offset0:2 offset1:3
    ds_read_b32 v48, v5 offset:128
    ds_read_b128 v[52:55], v4 offset:0
    ds_read_b128 v[56:59], v160 offset:0
    v_mov_b32 v108, 0
    v_mov_b32 v109, 0
    v_mov_b32 v110, 0
    v_mov_b32 v111, 0
    v_mov_b32 v112, 0
    v_mov_b32 v113, 0
    v_mov_b32 v114, 0
    v_mov_b32 v115, 0
    v_mov_b32 v116, 0
    v_mov_b32 v117, 0
    v_mov_b32 v118, 0
    v_mov_b32 v119, 0
    v_mov_b32 v120, 0
    v_mov_b32 v121, 0
    v_mov_b32 v122, 0
    v_mov_b32 v123, 0
    v_max3_f32 v156, v68, v69, v156
    v_max3_f32 v156, v70, v71, v156
    v_max3_f32 v156, v72, v73, v156
    v_max3_f32 v156, v74, v75, v156
    v_max3_f32 v156, v76, v77, v156
    v_max3_f32 v156, v78, v79, v156
    v_max3_f32 v156, v80, v81, v156
    v_max3_f32 v156, v82, v83, v156
    v_mov_b32 v10, v156
    s_nop 1
    v_permlane32_swap_b32 v156, v10
    v_max_f32 v156, v156, v10
    v_sub_f32 v10, 0, v156
    v_cvt_pk_bf16_f32 v11, v10, 1.0
    v_lshlrev_b32 v12, 16, v11
    v_sub_f32 v12, v10, v12
    v_cvt_pk_bf16_f32 v12, v12, 0
    v_cmp_gt_u32 vcc, 32, v1
    s_nop 1
    v_cndmask_b32 v25, v12, v11, vcc
    s_cmp_ge_u32 s15, 8
    s_cselect_b32 s16, s36, s37
    v_mov_b32 v41, s16
    s_waitcnt lgkmcnt(4)
    v_mfma_f32_32x32x16_bf16 v[68:83], v[36:39], v[20:23], v[124:139]
    v_mfma_f32_32x32x8_bf16 v[68:83], v[40:41], v[24:25], v[68:83]
    s_nop 7
    s_nop 3
    v_exp_f32 v68, v68
    v_exp_f32 v69, v69
    s_cmp_ge_u32 s15, 7
    s_cselect_b32 s16, s36, s37
    v_mov_b32 v49, s16
    v_exp_f32 v70, v70
    v_exp_f32 v71, v71
    v_exp_f32 v72, v72
    s_waitcnt lgkmcnt(2)
    v_mfma_f32_32x32x16_bf16 v[84:99], v[44:47], v[20:23], 0
    ds_read2st64_b64 v[36:39], v3 offset0:4 offset1:5
    ds_read_b32 v40, v5 offset:256
    v_exp_f32 v73, v73
    v_exp_f32 v74, v74
    v_exp_f32 v75, v75
    v_exp_f32 v76, v76
    v_cvt_pk_bf16_f32 v100, v68, v69
    v_cvt_pk_bf16_f32 v101, v70, v71
    v_cvt_pk_bf16_f32 v102, v72, v73
    v_cvt_pk_bf16_f32 v103, v74, v75
    v_mfma_f32_32x32x8_bf16 v[84:99], v[48:49], v[24:25], v[84:99]
    ds_read_b128 v[60:63], v4 offset:1280
    ds_read_b128 v[64:67], v160 offset:1280
    v_exp_f32 v77, v77
    v_exp_f32 v78, v78
    v_exp_f32 v79, v79
    v_exp_f32 v80, v80
    v_exp_f32 v81, v81
    s_waitcnt lgkmcnt(4)
    v_mfma_f32_32x32x16_bf16 v[108:123], v[52:55], v[100:103], v[108:123]
    v_exp_f32 v82, v82
    v_exp_f32 v83, v83
    v_cvt_pk_bf16_f32 v104, v76, v77
    v_cvt_pk_bf16_f32 v105, v78, v79
    v_cvt_pk_bf16_f32 v106, v80, v81
    v_cvt_pk_bf16_f32 v107, v82, v83
    v_exp_f32 v84, v84
    v_exp_f32 v85, v85
    v_mfma_f32_32x32x16_bf16 v[108:123], v[56:59], v[104:107], v[108:123]
    s_cmp_ge_u32 s15, 6
    s_cselect_b32 s16, s36, s37
    v_mov_b32 v41, s16
    v_exp_f32 v86, v86
    v_exp_f32 v87, v87
    v_exp_f32 v88, v88
    s_waitcnt lgkmcnt(2)
    v_mfma_f32_32x32x16_bf16 v[68:83], v[36:39], v[20:23], 0
    ds_read2st64_b64 v[44:47], v3 offset0:6 offset1:7
    ds_read_b32 v48, v5 offset:384
    v_exp_f32 v89, v89
    v_exp_f32 v90, v90
    v_exp_f32 v91, v91
    v_exp_f32 v92, v92
    v_cvt_pk_bf16_f32 v100, v84, v85
    v_cvt_pk_bf16_f32 v101, v86, v87
    v_cvt_pk_bf16_f32 v102, v88, v89
    v_cvt_pk_bf16_f32 v103, v90, v91
    v_mfma_f32_32x32x8_bf16 v[68:83], v[40:41], v[24:25], v[68:83]
    ds_read_b128 v[52:55], v4 offset:2560
    ds_read_b128 v[56:59], v160 offset:2560
    v_exp_f32 v93, v93
    v_exp_f32 v94, v94
    v_exp_f32 v95, v95
    v_exp_f32 v96, v96
    v_exp_f32 v97, v97
    s_waitcnt lgkmcnt(4)
    v_mfma_f32_32x32x16_bf16 v[108:123], v[60:63], v[100:103], v[108:123]
    v_exp_f32 v98, v98
    v_exp_f32 v99, v99
    v_cvt_pk_bf16_f32 v104, v92, v93
    v_cvt_pk_bf16_f32 v105, v94, v95
    v_cvt_pk_bf16_f32 v106, v96, v97
    v_cvt_pk_bf16_f32 v107, v98, v99
    v_exp_f32 v68, v68
    v_exp_f32 v69, v69
    v_mfma_f32_32x32x16_bf16 v[108:123], v[64:67], v[104:107], v[108:123]
    s_cmp_ge_u32 s15, 5
    s_cselect_b32 s16, s36, s37
    v_mov_b32 v49, s16
    v_exp_f32 v70, v70
    v_exp_f32 v71, v71
    v_exp_f32 v72, v72
    s_waitcnt lgkmcnt(2)
    v_mfma_f32_32x32x16_bf16 v[84:99], v[44:47], v[20:23], 0
    ds_read2st64_b64 v[36:39], v3 offset0:8 offset1:9
    ds_read_b32 v40, v5 offset:512
    v_exp_f32 v73, v73
    v_exp_f32 v74, v74
    v_exp_f32 v75, v75
    v_exp_f32 v76, v76
    v_cvt_pk_bf16_f32 v100, v68, v69
    v_cvt_pk_bf16_f32 v101, v70, v71
    v_cvt_pk_bf16_f32 v102, v72, v73
    v_cvt_pk_bf16_f32 v103, v74, v75
    v_mfma_f32_32x32x8_bf16 v[84:99], v[48:49], v[24:25], v[84:99]
    ds_read_b128 v[60:63], v4 offset:3840
    ds_read_b128 v[64:67], v160 offset:3840
    v_exp_f32 v77, v77
    v_exp_f32 v78, v78
    v_exp_f32 v79, v79
    v_exp_f32 v80, v80
    v_exp_f32 v81, v81
    s_waitcnt lgkmcnt(4)
    v_mfma_f32_32x32x16_bf16 v[108:123], v[52:55], v[100:103], v[108:123]
    v_exp_f32 v82, v82
    v_exp_f32 v83, v83
    v_cvt_pk_bf16_f32 v104, v76, v77
    v_cvt_pk_bf16_f32 v105, v78, v79
    v_cvt_pk_bf16_f32 v106, v80, v81
    v_cvt_pk_bf16_f32 v107, v82, v83
    v_exp_f32 v84, v84
    v_exp_f32 v85, v85
    v_mfma_f32_32x32x16_bf16 v[108:123], v[56:59], v[104:107], v[108:123]
    s_cmp_ge_u32 s15, 4
    s_cselect_b32 s16, s36, s37
    v_mov_b32 v41, s16
    v_exp_f32 v86, v86
    v_exp_f32 v87, v87
    v_exp_f32 v88, v88
    s_waitcnt lgkmcnt(2)
    v_mfma_f32_32x32x16_bf16 v[68:83], v[36:39], v[20:23], 0
    ds_read2st64_b64 v[44:47], v3 offset0:10 offset1:11
    ds_read_b32 v48, v5 offset:640
    v_exp_f32 v89, v89
    v_exp_f32 v90, v90
    v_exp_f32 v91, v91
    v_exp_f32 v92, v92
    v_cvt_pk_bf16_f32 v100, v84, v85
    v_cvt_pk_bf16_f32 v101, v86, v87
    v_cvt_pk_bf16_f32 v102, v88, v89
    v_cvt_pk_bf16_f32 v103, v90, v91
    v_mfma_f32_32x32x8_bf16 v[68:83], v[40:41], v[24:25], v[68:83]
    ds_read_b128 v[52:55], v4 offset:5120
    ds_read_b128 v[56:59], v160 offset:5120
    v_exp_f32 v93, v93
    v_exp_f32 v94, v94
    v_exp_f32 v95, v95
    v_exp_f32 v96, v96
    v_exp_f32 v97, v97
    s_waitcnt lgkmcnt(4)
    v_mfma_f32_32x32x16_bf16 v[108:123], v[60:63], v[100:103], v[108:123]
    v_exp_f32 v98, v98
    v_exp_f32 v99, v99
    v_cvt_pk_bf16_f32 v104, v92, v93
    v_cvt_pk_bf16_f32 v105, v94, v95
    v_cvt_pk_bf16_f32 v106, v96, v97
    v_cvt_pk_bf16_f32 v107, v98, v99
    v_exp_f32 v68, v68
    v_exp_f32 v69, v69
    v_mfma_f32_32x32x16_bf16 v[108:123], v[64:67], v[104:107], v[108:123]
    s_cmp_ge_u32 s15, 3
    s_cselect_b32 s16, s36, s37
    v_mov_b32 v49, s16
    v_exp_f32 v70, v70
    v_exp_f32 v71, v71
    v_exp_f32 v72, v72
    s_waitcnt lgkmcnt(2)
    v_mfma_f32_32x32x16_bf16 v[84:99], v[44:47], v[20:23], 0
    ds_read2st64_b64 v[36:39], v3 offset0:12 offset1:13
    ds_read_b32 v40, v5 offset:768
    v_exp_f32 v73, v73
    v_exp_f32 v74, v74
    v_exp_f32 v75, v75
    v_exp_f32 v76, v76
    v_cvt_pk_bf16_f32 v100, v68, v69
    v_cvt_pk_bf16_f32 v101, v70, v71
    v_cvt_pk_bf16_f32 v102, v72, v73
    v_cvt_pk_bf16_f32 v103, v74, v75
    v_mfma_f32_32x32x8_bf16 v[84:99], v[48:49], v[24:25], v[84:99]
    ds_read_b128 v[60:63], v4 offset:6400
    ds_read_b128 v[64:67], v160 offset:6400
    v_exp_f32 v77, v77
    v_exp_f32 v78, v78
    v_exp_f32 v79, v79
    v_exp_f32 v80, v80
    v_exp_f32 v81, v81
    s_waitcnt lgkmcnt(4)
    v_mfma_f32_32x32x16_bf16 v[108:123], v[52:55], v[100:103], v[108:123]
    v_exp_f32 v82, v82
    v_exp_f32 v83, v83
    v_cvt_pk_bf16_f32 v104, v76, v77
    v_cvt_pk_bf16_f32 v105, v78, v79
    v_cvt_pk_bf16_f32 v106, v80, v81
    v_cvt_pk_bf16_f32 v107, v82, v83
    v_exp_f32 v84, v84
    v_exp_f32 v85, v85
    v_mfma_f32_32x32x16_bf16 v[108:123], v[56:59], v[104:107], v[108:123]
    s_cmp_ge_u32 s15, 2
    s_cselect_b32 s16, s36, s37
    v_mov_b32 v41, s16
    v_exp_f32 v86, v86
    v_exp_f32 v87, v87
    v_exp_f32 v88, v88
    s_waitcnt lgkmcnt(2)
    v_mfma_f32_32x32x16_bf16 v[68:83], v[36:39], v[20:23], 0
    ds_read2st64_b64 v[44:47], v3 offset0:14 offset1:15
    ds_read_b32 v48, v5 offset:896
    v_exp_f32 v89, v89
    v_exp_f32 v90, v90
    v_exp_f32 v91, v91
    v_exp_f32 v92, v92
    v_cvt_pk_bf16_f32 v100, v84, v85
    v_cvt_pk_bf16_f32 v101, v86, v87
    v_cvt_pk_bf16_f32 v102, v88, v89
    v_cvt_pk_bf16_f32 v103, v90, v91
    v_mfma_f32_32x32x8_bf16 v[68:83], v[40:41], v[24:25], v[68:83]
    ds_read_b128 v[52:55], v4 offset:7680
    ds_read_b128 v[56:59], v160 offset:7680
    v_exp_f32 v93, v93
    v_exp_f32 v94, v94
    v_exp_f32 v95, v95
    v_exp_f32 v96, v96
    v_exp_f32 v97, v97
    s_waitcnt lgkmcnt(4)
    v_mfma_f32_32x32x16_bf16 v[108:123], v[60:63], v[100:103], v[108:123]
    v_exp_f32 v98, v98
    v_exp_f32 v99, v99
    v_cvt_pk_bf16_f32 v104, v92, v93
    v_cvt_pk_bf16_f32 v105, v94, v95
    v_cvt_pk_bf16_f32 v106, v96, v97
    v_cvt_pk_bf16_f32 v107, v98, v99
    v_exp_f32 v68, v68
    v_exp_f32 v69, v69
    v_mfma_f32_32x32x16_bf16 v[108:123], v[64:67], v[104:107], v[108:123]
    s_cmp_ge_u32 s15, 1
    s_cselect_b32 s16, s36, s37
    v_mov_b32 v49, s16
    v_exp_f32 v70, v70
    v_exp_f32 v71, v71
    v_exp_f32 v72, v72
    s_waitcnt lgkmcnt(2)
    v_mfma_f32_32x32x16_bf16 v[84:99], v[44:47], v[20:23], 0
    ds_read2st64_b64 v[36:39], v3 offset0:16 offset1:17
    ds_read_b32 v40, v5 offset:1024
    v_exp_f32 v73, v73
    v_exp_f32 v74, v74
    v_exp_f32 v75, v75
    v_exp_f32 v76, v76
    v_cvt_pk_bf16_f32 v100, v68, v69
    v_cvt_pk_bf16_f32 v101, v70, v71
    v_cvt_pk_bf16_f32 v102, v72, v73
    v_cvt_pk_bf16_f32 v103, v74, v75
    v_mfma_f32_32x32x8_bf16 v[84:99], v[48:49], v[24:25], v[84:99]
    ds_read_b128 v[60:63], v4 offset:8960
    ds_read_b128 v[64:67], v160 offset:8960
    v_exp_f32 v77, v77
    v_exp_f32 v78, v78
    v_exp_f32 v79, v79
    v_exp_f32 v80, v80
    v_exp_f32 v81, v81
    s_waitcnt lgkmcnt(4)
    v_mfma_f32_32x32x16_bf16 v[108:123], v[52:55], v[100:103], v[108:123]
    v_exp_f32 v82, v82
    v_exp_f32 v83, v83
    v_cvt_pk_bf16_f32 v104, v76, v77
    v_cvt_pk_bf16_f32 v105, v78, v79
    v_cvt_pk_bf16_f32 v106, v80, v81
    v_cvt_pk_bf16_f32 v107, v82, v83
    v_exp_f32 v84, v84
    v_exp_f32 v85, v85
    v_mfma_f32_32x32x16_bf16 v[108:123], v[56:59], v[104:107], v[108:123]
    v_mov_b32 v41, s36
    v_exp_f32 v86, v86
    v_exp_f32 v87, v87
    v_exp_f32 v88, v88
    s_waitcnt lgkmcnt(2)
    v_mfma_f32_32x32x16_bf16 v[68:83], v[36:39], v[20:23], v[140:155]
    v_exp_f32 v89, v89
    v_exp_f32 v90, v90
    v_exp_f32 v91, v91
    v_exp_f32 v92, v92
    v_cvt_pk_bf16_f32 v100, v84, v85
    v_cvt_pk_bf16_f32 v101, v86, v87
    v_cvt_pk_bf16_f32 v102, v88, v89
    v_cvt_pk_bf16_f32 v103, v90, v91
    v_mfma_f32_32x32x8_bf16 v[68:83], v[40:41], v[24:25], v[68:83]
    ds_read_b128 v[52:55], v4 offset:10240
    ds_read_b128 v[56:59], v160 offset:10240
    v_exp_f32 v93, v93
    v_exp_f32 v94, v94
    v_exp_f32 v95, v95
    v_exp_f32 v96, v96
    v_exp_f32 v97, v97
    s_waitcnt lgkmcnt(2)
    v_mfma_f32_32x32x16_bf16 v[108:123], v[60:63], v[100:103], v[108:123]
    v_exp_f32 v98, v98
    v_exp_f32 v99, v99
    v_cvt_pk_bf16_f32 v104, v92, v93
    v_cvt_pk_bf16_f32 v105, v94, v95
    v_cvt_pk_bf16_f32 v106, v96, v97
    v_cvt_pk_bf16_f32 v107, v98, v99
    v_exp_f32 v68, v68
    v_exp_f32 v69, v69
    v_mfma_f32_32x32x16_bf16 v[108:123], v[64:67], v[104:107], v[108:123]
    v_exp_f32 v70, v70
    v_exp_f32 v71, v71
    v_exp_f32 v72, v72
    s_nop 0
    v_exp_f32 v73, v73
    v_exp_f32 v74, v74
    v_exp_f32 v75, v75
    v_exp_f32 v76, v76
    v_cvt_pk_bf16_f32 v100, v68, v69
    v_cvt_pk_bf16_f32 v101, v70, v71
    v_cvt_pk_bf16_f32 v102, v72, v73
    v_cvt_pk_bf16_f32 v103, v74, v75
    v_exp_f32 v77, v77
    v_exp_f32 v78, v78
    v_exp_f32 v79, v79
    v_exp_f32 v80, v80
    v_exp_f32 v81, v81
    s_waitcnt lgkmcnt(0)
    v_mfma_f32_32x32x16_bf16 v[108:123], v[52:55], v[100:103], v[108:123]
    v_exp_f32 v82, v82
    v_exp_f32 v83, v83
    v_cvt_pk_bf16_f32 v104, v76, v77
    v_cvt_pk_bf16_f32 v105, v78, v79
    v_cvt_pk_bf16_f32 v106, v80, v81
    v_cvt_pk_bf16_f32 v107, v82, v83
    s_nop 1
    v_mfma_f32_32x32x16_bf16 v[108:123], v[56:59], v[104:107], v[108:123]
    v_mov_b32 v41, s36
    v_mov_b32 v49, s36
    s_nop 12
    v_mov_b32 v10, 1904214016
    v_cmp_nlt_f32 vcc, v118, v10
    v_max3_f32 v11, |v108|, |v109|, |v110|
    v_max3_f32 v12, |v111|, |v112|, |v113|
    v_max3_f32 v13, |v114|, |v115|, |v116|
    v_max3_f32 v11, v11, v12, v13
    v_max3_f32 v11, v11, |v117|, |v117|
    s_bfm_b64 s[32:33], 32, 0
    s_and_b64 s[32:33], vcc, s[32:33]
    v_mov_b32 v10, 0x7f800000
    v_cmp_nlt_f32 vcc, v11, v10
    s_nop 1
    s_or_b64 vcc, vcc, s[32:33]
    s_cbranch_scc0 k2_attn_kernel_aepi
    v_mov_b32 v10, 1065353216
    v_cmp_gt_u32 vcc, 32, v1
    s_nop 1
    v_cndmask_b32 v25, 0, v10, vcc
    s_sub_u32 s21, 8, s15
    s_cmp_ge_u32 s15, 8
    s_cselect_b32 s21, 0, s21
    s_mov_b32 s30, s21
    s_mov_b32 s31, s53
    v_mov_b32 v156, s29
k2_attn_kernel_a1:
    s_add_u32 s17, s31, s21
    s_lshl_b32 s16, s17, 10
    v_add_u32 v3, s16, v6
    s_mul_i32 s16, s17, 1280
    v_add_u32 v4, s16, v7
    v_add_u32 v160, s16, v161
    s_lshl_b32 s16, s17, 7
    v_add_u32 v5, s16, v8
    ds_read2st64_b64 v[36:39], v3 offset0:0 offset1:1
    ds_read_b32 v40, v5 offset:0
    s_cmp_eq_u32 s21, 8
    s_cbranch_scc1 k2_attn_kernel_cm0_d
    s_cmp_eq_u32 s21, 0
    s_cbranch_scc1 k2_attn_kernel_cm0_f
    v_mov_b32 v84, 0
    v_mov_b32 v85, 0
    v_mov_b32 v86, 0
    v_mov_b32 v87, 0
    v_mov_b32 v88, 0
    v_mov_b32 v89, 0
    v_mov_b32 v90, 0
    v_mov_b32 v91, 0
    v_mov_b32 v92, 0
    v_mov_b32 v93, 0
    v_mov_b32 v94, 0
    v_mov_b32 v95, 0
    v_mov_b32 v96, 0
    v_mov_b32 v97, 0
    v_mov_b32 v98, 0
    v_mov_b32 v99, 0
    s_branch k2_attn_kernel_cm0_e
k2_attn_kernel_cm0_d:
    v_mov_b32 v84, v140
    v_mov_b32 v85, v141
    v_mov_b32 v86, v142
    v_mov_b32 v87, v143
    v_mov_b32 v88, v144
    v_mov_b32 v89, v145
    v_mov_b32 v90, v146
    v_mov_b32 v91, v147
    v_mov_b32 v92, v148
    v_mov_b32 v93, v149
    v_mov_b32 v94, v150
    v_mov_b32 v95, v151
    v_mov_b32 v96, v152
    v_mov_b32 v97, v153
    v_mov_b32 v98, v154
    v_mov_b32 v99, v155
    s_branch k2_attn_kernel_cm0_e
k2_attn_kernel_cm0_f:
    v_mov_b32 v84, v124
    v_mov_b32 v85, v125
    v_mov_b32 v86, v126
    v_mov_b32 v87, v127
    v_mov_b32 v88, v128
    v_mov_b32 v89, v129
    v_mov_b32 v90, v130
    v_mov_b32 v91, v131
    v_mov_b32 v92, v132
    v_mov_b32 v93, v133
    v_mov_b32 v94, v134
    v_mov_b32 v95, v135
    v_mov_b32 v96, v136
    v_mov_b32 v97, v137
    v_mov_b32 v98, v138
    v_mov_b32 v99, v139
k2_attn_kernel_cm0_e:
    s_waitcnt lgkmcnt(0)
    s_nop 0
    v_mfma_f32_32x32x16_bf16 v[68:83], v[36:39], v[20:23], v[84:99]
    v_mfma_f32_32x32x8_bf16 v[68:83], v[40:41], v[24:25], v[68:83]
    s_nop 11
    v_max3_f32 v156, v68, v69, v156
    v_max3_f32 v156, v70, v71, v156
    v_max3_f32 v156, v72, v73, v156
    v_max3_f32 v156, v74, v75, v156
    v_max3_f32 v156, v76, v77, v156
    v_max3_f32 v156, v78, v79, v156
    v_max3_f32 v156, v80, v81, v156
    v_max3_f32 v156, v82, v83, v156
    s_add_u32 s21, s21, 1
    s_cmp_le_u32 s21, 8
    s_cbranch_scc1 k2_attn_kernel_a1
    v_mov_b32 v10, v156
    s_nop 1
    v_permlane32_swap_b32 v156, v10
    v_max_f32 v156, v156, v10
    v_sub_f32 v10, 0, v156
    v_cvt_pk_bf16_f32 v11, v10, 1.0
    v_lshlrev_b32 v12, 16, v11
    v_sub_f32 v12, v10, v12
    v_cvt_pk_bf16_f32 v12, v12, 0
    v_cmp_gt_u32 vcc, 32, v1
    s_nop 1
    v_cndmask_b32 v25, v12, v11, vcc
    v_mov_b32 v108, 0
    v_mov_b32 v109, 0
    v_mov_b32 v110, 0
    v_mov_b32 v111, 0
    v_mov_b32 v112, 0
    v_mov_b32 v113, 0
    v_mov_b32 v114, 0
    v_mov_b32 v115, 0
    v_mov_b32 v116, 0
    v_mov_b32 v117, 0
    v_mov_b32 v118, 0
    v_mov_b32 v119, 0
    v_mov_b32 v120, 0
    v_mov_b32 v121, 0
    v_mov_b32 v122, 0
    v_mov_b32 v123, 0
    s_mov_b32 s21, s30
k2_attn_kernel_a2:
    s_add_u32 s17, s31, s21
    s_lshl_b32 s16, s17, 10
    v_add_u32 v3, s16, v6
    s_mul_i32 s16, s17, 1280
    v_add_u32 v4, s16, v7
    v_add_u32 v160, s16, v161
    s_lshl_b32 s16, s17, 7
    v_add_u32 v5, s16, v8
    ds_read2st64_b64 v[36:39], v3 offset0:0 offset1:1
    ds_read_b32 v40, v5 offset:0
    ds_read_b128 v[52:55], v4 offset:0
    ds_read_b128 v[56:59], v160 offset:0
    s_cmp_eq_u32 s21, 8
    s_cbranch_scc1 k2_attn_kernel_cm1_d
    s_cmp_eq_u32 s21, 0
    s_cbranch_scc1 k2_attn_kernel_cm1_f
    v_mov_b32 v84, 0
    v_mov_b32 v85, 0
    v_mov_b32 v86, 0
    v_mov_b32 v87, 0
    v_mov_b32 v88, 0
    v_mov_b32 v89, 0
    v_mov_b32 v90, 0
    v_mov_b32 v91, 0
    v_mov_b32 v92, 0
    v_mov_b32 v93, 0
    v_mov_b32 v94, 0
    v_mov_b32 v95, 0
    v_mov_b32 v96, 0
    v_mov_b32 v97, 0
    v_mov_b32 v98, 0
    v_mov_b32 v99, 0
    s_branch k2_attn_kernel_cm1_e
k2_attn_kernel_cm1_d:
    v_mov_b32 v84, v140
    v_mov_b32 v85, v141
    v_mov_b32 v86, v142
    v_mov_b32 v87, v143
    v_mov_b32 v88, v144
    v_mov_b32 v89, v145
    v_mov_b32 v90, v146
    v_mov_b32 v91, v147
    v_mov_b32 v92, v148
    v_mov_b32 v93, v149
    v_mov_b32 v94, v150
    v_mov_b32 v95, v151
    v_mov_b32 v96, v152
    v_mov_b32 v97, v153
    v_mov_b32 v98, v154
    v_mov_b32 v99, v155
    s_branch k2_attn_kernel_cm1_e
k2_attn_kernel_cm1_f:
    v_mov_b32 v84, v124
    v_mov_b32 v85, v125
    v_mov_b32 v86, v126
    v_mov_b32 v87, v127
    v_mov_b32 v88, v128
    v_mov_b32 v89, v129
    v_mov_b32 v90, v130
    v_mov_b32 v91, v131
    v_mov_b32 v92, v132
    v_mov_b32 v93, v133
    v_mov_b32 v94, v134
    v_mov_b32 v95, v135
    v_mov_b32 v96, v136
    v_mov_b32 v97, v137
    v_mov_b32 v98, v138
    v_mov_b32 v99, v139
k2_attn_kernel_cm1_e:
    s_waitcnt lgkmcnt(2)
    s_nop 0
    v_mfma_f32_32x32x16_bf16 v[68:83], v[36:39], v[20:23], v[84:99]
    v_mfma_f32_32x32x8_bf16 v[68:83], v[40:41], v[24:25], v[68:83]
    s_nop 11
    v_exp_f32 v68, v68
    v_exp_f32 v69, v69
    v_exp_f32 v70, v70
    v_exp_f32 v71, v71
    v_exp_f32 v72, v72
    v_exp_f32 v73, v73
    v_exp_f32 v74, v74
    v_exp_f32 v75, v75
    v_exp_f32 v76, v76
    v_exp_f32 v77, v77
    v_exp_f32 v78, v78
    v_exp_f32 v79, v79
    v_exp_f32 v80, v80
    v_exp_f32 v81, v81
    v_exp_f32 v82, v82
    v_exp_f32 v83, v83
    v_cvt_pk_bf16_f32 v100, v68, v69
    v_cvt_pk_bf16_f32 v101, v70, v71
    v_cvt_pk_bf16_f32 v102, v72, v73
    v_cvt_pk_bf16_f32 v103, v74, v75
    v_cvt_pk_bf16_f32 v104, v76, v77
    v_cvt_pk_bf16_f32 v105, v78, v79
    v_cvt_pk_bf16_f32 v106, v80, v81
    v_cvt_pk_bf16_f32 v107, v82, v83
    s_waitcnt lgkmcnt(0)
    v_mfma_f32_32x32x16_bf16 v[108:123], v[52:55], v[100:103], v[108:123]
    v_mfma_f32_32x32x16_bf16 v[108:123], v[56:59], v[104:107], v[108:123]
    s_add_u32 s21, s21, 1
    s_cmp_le_u32 s21, 8
    s_cbranch_scc1 k2_attn_kernel_a2
    s_nop 12
k2_attn_kernel_aepi:
    v_mov_b32 v10, 1
    s_mov_b64 exec, 1
    ds_add_rtn_u32 v11, v157, v10 offset:16
    s_mov_b64 exec, -1
    s_waitcnt lgkmcnt(0)
    v_readfirstlane_b32 s50, v11
    s_nop 1
    s_cmp_ge_u32 s50, 8
    s_cbranch_scc1 k2_attn_kernel_claim1
    s_lshl_b32 s51, s13, 3
    s_add_u32 s51, s51, s50
    s_lshl_b32 s16, s12, 16
    s_lshl_b32 s17, s51, 10
    s_add_u32 s16, s16, s17
    buffer_load_dwordx2 v[20:21], v34, s[8:11], s16 offen
    buffer_load_dwordx2 v[22:23], v34, s[8:11], s16 offen offset:512
    s_lshl_b32 s17, s51, 8
    s_add_u32 s17, s17, s52
    v_and_b32 v10, 31, v1
    v_lshlrev_b32 v11, 3, v10
    buffer_load_dword v24, v11, s[8:11], s17 offen
    v_lshlrev_b32 v12, 2, v10
    s_lshl_b32 s16, s51, 7
    s_add_u32 s16, s16, 14680064
    buffer_load_dword v26, v12, s[8:11], s16 offen
k2_attn_kernel_claim1:
    v_mov_b32 v10, v118
    v_mov_b32 v11, v118
    s_nop 1
    v_permlane32_swap_b32 v10, v11
    v_rcp_f32 v12, v10
    s_nop 0
    v_mul_f32 v12, v12, v27
    v_mul_f32 v108, v108, v12
    v_mul_f32 v109, v109, v12
    v_mul_f32 v110, v110, v12
    v_mul_f32 v111, v111, v12
    v_mul_f32 v112, v112, v12
    v_mul_f32 v113, v113, v12
    v_mul_f32 v114, v114, v12
    v_mul_f32 v115, v115, v12
    v_mul_f32 v116, v116, v12
    v_mul_f32 v117, v117, v12
    v_cvt_pk_bf16_f32 v100, v108, v109
    v_cvt_pk_bf16_f32 v101, v110, v111
    v_cvt_pk_bf16_f32 v102, v112, v113
    v_cvt_pk_bf16_f32 v103, v114, v115
    v_cvt_pk_bf16_f32 v104, v116, v117
    s_lshl_b32 s16, s15, 5
    s_add_u32 s16, s16, s12
    s_lshl_b32 s17, s16, 10
    s_add_u32 s17, s17, 16777216
    buffer_store_dwordx4 v[100:103], v2, s[8:11], s17 offen sc1
    s_lshl_b32 s17, s16, 7
    s_add_u32 s17, s17, 20971520
    v_lshlrev_b32 v14, 2, v1
    s_bfm_b64 exec, 32, 0
    buffer_store_dword v104, v14, s[8:11], s17 offen sc1
    s_mov_b64 exec, -1
    s_cmp_lt_u32 s50, 8
    s_cbranch_scc1 k2_attn_kernel_aitem
k2_attn_kernel_done:
    s_endpgm
k2_attn_kernel_loader:
    s_sub_u32 s35, s14, 8
    s_lshl_b32 s34, s35, 10
    s_add_u32 s43, s24, 2097152
    s_add_u32 s44, s25, 2621440
    s_add_u32 s45, s26, 262144
    s_lshl_b32 s46, s35, 2
    v_add_u32 v18, s46, v157
    s_waitcnt lgkmcnt(0)
    s_mov_b32 s8, s4
    s_and_b32 s9, s5, 0xffff
    s_mov_b32 s10, 23068672
    s_mov_b32 s11, 0x00020000
    s_mov_b32 s20, 1
k2_attn_kernel_lgrp:
    s_add_u32 s16, s13, s20
    s_and_b32 s16, s16, 7
    s_lshl_b32 s48, s16, 13
    s_add_u32 s48, s48, s43
    s_add_u32 s48, s48, s34
    s_lshl_b32 s49, s20, 13
    s_add_u32 s49, s49, s34
    s_add_u32 m0, s49, 0
    s_add_u32 s19, s48, 0
    buffer_load_dwordx4 v2, s[8:11], s19 offen lds
    s_add_u32 m0, s49, 2048
    s_add_u32 s19, s48, 2048
    buffer_load_dwordx4 v2, s[8:11], s19 offen lds
    s_add_u32 m0, s49, 4096
    s_add_u32 s19, s48, 4096
    buffer_load_dwordx4 v2, s[8:11], s19 offen lds
    s_add_u32 m0, s49, 6144
    s_add_u32 s19, s48, 6144
    buffer_load_dwordx4 v2, s[8:11], s19 offen lds
    s_lshl_b32 s48, s16, 11
    s_add_u32 s48, s48, s45
    s_lshl_b32 s18, s35, 9
    s_add_u32 s48, s48, s18
    s_lshl_b32 s49, s20, 10
    s_lshl_b32 s18, s35, 8
    s_add_u32 s49, s49, s18
    s_add_u32 s49, s49, 147456
    s_add_u32 m0, s49, 0
    s_add_u32 s19, s48, 0
    buffer_load_dword v163, s[8:11], s19 offen lds
    s_add_u32 m0, s49, 512
    s_add_u32 s19, s48, 1024
    buffer_load_dword v163, s[8:11], s19 offen lds
    s_mul_i32 s48, s16, 10240
    s_add_u32 s48, s48, s44
    s_add_u32 s48, s48, s34
    s_mul_i32 s49, s20, 10240
    s_add_u32 s49, s49, s34
    s_add_u32 s49, s49, 65536
    s_add_u32 m0, s49, 0
    s_add_u32 s19, s48, 0
    buffer_load_dwordx4 v2, s[8:11], s19 offen lds
    s_add_u32 m0, s49, 2048
    s_add_u32 s19, s48, 2048
    buffer_load_dwordx4 v2, s[8:11], s19 offen lds
    s_add_u32 m0, s49, 4096
    s_add_u32 s19, s48, 4096
    buffer_load_dwordx4 v2, s[8:11], s19 offen lds
    s_add_u32 m0, s49, 6144
    s_add_u32 s19, s48, 6144
    buffer_load_dwordx4 v2, s[8:11], s19 offen lds
    s_add_u32 m0, s49, 8192
    s_add_u32 s19, s48, 8192
    buffer_load_dwordx4 v2, s[8:11], s19 offen lds
    s_cmp_eq_u32 s20, 1
    s_cbranch_scc0 k2_attn_kernel_lg1
    s_barrier
    s_barrier
    v_mov_b32 v10, 1
    s_mov_b64 exec, 1
    ds_add_u32 v18, v10
    s_mov_b64 exec, -1
    s_branch k2_attn_kernel_lg2
k2_attn_kernel_lg1:
    s_waitcnt vmcnt(11)
    v_mov_b32 v10, 1
    s_mov_b64 exec, 1
    ds_add_u32 v18, v10
    s_mov_b64 exec, -1
k2_attn_kernel_lg2:
    s_add_u32 s20, s20, 1
    s_cmp_lt_u32 s20, 8
    s_cbranch_scc1 k2_attn_kernel_lgrp
    s_waitcnt vmcnt(0)
    v_mov_b32 v10, 1
    s_mov_b64 exec, 1
    ds_add_u32 v18, v10
    s_mov_b64 exec, -1
k2_attn_kernel_pollld:
    ds_read_b32 v10, v157 offset:8
    s_waitcnt lgkmcnt(0)
    v_readfirstlane_b32 s16, v10
    s_nop 1
    s_cmp_ge_u32 s16, 8
    s_cbranch_scc1 k2_attn_kernel_pollokld
    s_sleep 1
    s_branch k2_attn_kernel_pollld
k2_attn_kernel_pollokld:
    s_lshl_b32 s21, s13, 3
    s_sub_u32 s21, s21, 8
    s_lshl_b32 s16, s21, 10
    s_add_u32 s28, s24, s16
    s_add_u32 s19, s28, s34
    s_add_u32 s18, s34, 0
    s_mov_b32 s20, s35
k2_attn_kernel_lg_0:
    s_mov_b32 m0, s18
    s_add_u32 s18, s18, 2048
    buffer_load_dwordx4 v2, s[8:11], s19 offen lds
    s_add_u32 s19, s19, 2048
    s_add_u32 s20, s20, 2
    s_cmp_lt_u32 s20, 16
    s_cbranch_scc1 k2_attn_kernel_lg_0
    s_lshl_b32 s16, s21, 8
    s_add_u32 s28, s26, s16
    s_lshl_b32 s18, s35, 9
    s_add_u32 s28, s28, s18
    s_lshl_b32 s18, s35, 8
    s_add_u32 s18, s18, 147456
    s_add_u32 m0, s18, 0
    s_add_u32 s19, s28, 0
    buffer_load_dword v163, s[8:11], s19 offen lds
    s_add_u32 m0, s18, 512
    s_add_u32 s19, s28, 1024
    buffer_load_dword v163, s[8:11], s19 offen lds
    s_add_u32 m0, s18, 1024
    s_add_u32 s19, s28, 2048
    buffer_load_dword v163, s[8:11], s19 offen lds
    s_add_u32 m0, s18, 1536
    s_add_u32 s19, s28, 3072
    buffer_load_dword v163, s[8:11], s19 offen lds
    s_mul_i32 s16, s21, 1280
    s_add_u32 s28, s25, s16
    s_add_u32 s19, s28, s34
    s_add_u32 s18, s34, 65536
    s_mov_b32 s20, s35
k2_attn_kernel_lg_1:
    s_mov_b32 m0, s18
    s_add_u32 s18, s18, 2048
    buffer_load_dwordx4 v2, s[8:11], s19 offen lds
    s_add_u32 s19, s19, 2048
    s_add_u32 s20, s20, 2
    s_cmp_lt_u32 s20, 20
    s_cbranch_scc1 k2_attn_kernel_lg_1
    s_waitcnt vmcnt(0)
    v_mov_b32 v10, 1
    s_mov_b64 exec, 1
    ds_add_u32 v157, v10 offset:12
    s_mov_b64 exec, -1
    s_lshl_b32 s16, s35, 1
    s_mul_i32 s16, s16, 12
    s_add_u32 s16, s16, 16
    s_load_dwordx2 s[48:49], s[0:1], s16
    s_lshr_b32 s17, s2, 3
    s_mul_i32 s17, s17, 20736
    v_lshlrev_b32 v11, 6, v1
    s_waitcnt lgkmcnt(0)
    s_mov_b32 s52, s48
    s_and_b32 s53, s49, 0xffff
    s_mov_b32 s54, 663552
    s_mov_b32 s55, 0x00020000
    buffer_load_dword v12, v11, s[52:55], s17 offen
    s_add_u32 s17, s17, 4096
    buffer_load_dword v12, v11, s[52:55], s17 offen
    s_add_u32 s17, s17, 4096
    buffer_load_dword v12, v11, s[52:55], s17 offen
    s_add_u32 s17, s17, 4096
    buffer_load_dword v12, v11, s[52:55], s17 offen
    s_add_u32 s17, s17, 4096
    buffer_load_dword v12, v11, s[52:55], s17 offen
    s_add_u32 s17, s17, 4096
    buffer_load_dword v12, v11, s[52:55], s17 offen
    s_waitcnt vmcnt(0)
    s_waitcnt lgkmcnt(0)
k2_attn_kernel_end:
    s_endpgm

.globl k3_out_kernel
.p2align 8
.type k3_out_kernel,@function
k3_out_kernel:
    s_cmp_ge_u32 s2, 216
    s_cbranch_scc1 k3_out_kernel_end
    s_load_dwordx2 s[4:5], s[0:1], 72
    s_load_dwordx2 s[6:7], s[0:1], 16
    s_load_dwordx2 s[32:33], s[0:1], 40
    s_load_dwordx2 s[34:35], s[0:1], 56
    v_and_b32 v1, 63, v0
    v_lshrrev_b32 v8, 6, v0
    s_and_b32 s26, s2, 7
    v_readfirstlane_b32 s22, v8
    s_lshr_b32 s27, s2, 3
    s_mul_i32 s28, s27, 57
    s_lshr_b32 s28, s28, 9
    s_mul_i32 s29, s28, 9
    s_sub_u32 s21, s27, s29
    s_lshl_b32 s28, s28, 3
    s_add_u32 s20, s26, s28
    s_cmp_ge_u32 s20, 22
    s_cbranch_scc1 k3_out_kernel_end
    s_cmp_ge_u32 s22, 6
    s_cbranch_scc0 k3_out_kernel_comp
    s_sub_u32 s23, s22, 6
    v_lshrrev_b32 v8, 3, v1
    v_and_b32 v9, 7, v1
    v_bfe_u32 v10, v1, 4, 1
    v_lshlrev_b32 v11, 2, v10
    v_xor_b32 v9, v9, v11
    v_lshlrev_b32 v9, 4, v9
    v_lshrrev_b32 v11, 2, v8
    v_lshlrev_b32 v11, 3, v11
    v_and_b32 v12, 3, v8
    v_add_u32 v11, v11, v12
    v_mul_u32_u24 v3, 1152, v11
    v_add_u32 v3, v3, v9
    v_lshrrev_b32 v11, 1, v8
    v_mul_u32_u24 v11, 18, v11
    v_lshlrev_b32 v12, 4, v10
    v_sub_u32 v12, 16, v12
    v_and_b32 v13, 1, v8
    v_add3_u32 v11, v11, v12, v13
    v_mul_u32_u24 v4, 1152, v11
    v_add_u32 v4, v4, v9
    s_waitcnt lgkmcnt(0)
    s_cmp_eq_u32 s23, 0
    s_cselect_b32 s12, s6, s32
    s_cselect_b32 s13, s7, s33
    s_and_b32 s13, s13, 0xffff
    s_mov_b32 s14, 663552
    s_mov_b32 s15, 0x00020000
    s_mul_i32 s26, s23, 73728
    s_mov_b32 m0, s26
    s_lshl_b32 s27, s21, 7
    s_lshl_b32 s36, s21, 2
    s_add_u32 s29, s36, 0
    s_and_b32 s29, s29, 31
    s_mul_i32 s29, s29, 20736
    s_add_u32 s29, s29, s27
    s_add_u32 s28, s29, 0
    buffer_load_dwordx4 v3, s[12:15], s28 offen lds
    s_add_u32 m0, m0, 1024
    s_add_u32 s28, s29, 4608
    buffer_load_dwordx4 v3, s[12:15], s28 offen lds
    s_add_u32 m0, m0, 1024
    s_add_u32 s29, s36, 1
    s_and_b32 s29, s29, 31
    s_mul_i32 s29, s29, 20736
    s_add_u32 s29, s29, s27
    s_add_u32 s28, s29, 2304
    buffer_load_dwordx4 v3, s[12:15], s28 offen lds
    s_add_u32 m0, m0, 1024
    s_add_u32 s28, s29, 6912
    buffer_load_dwordx4 v3, s[12:15], s28 offen lds
    s_add_u32 m0, m0, 1024
    s_add_u32 s29, s36, 2
    s_and_b32 s29, s29, 31
    s_mul_i32 s29, s29, 20736
    s_add_u32 s29, s29, s27
    s_add_u32 s28, s29, 0
    buffer_load_dwordx4 v3, s[12:15], s28 offen lds
    s_add_u32 m0, m0, 1024
    s_add_u32 s28, s29, 4608
    buffer_load_dwordx4 v3, s[12:15], s28 offen lds
    s_add_u32 m0, m0, 1024
    s_add_u32 s29, s36, 3
    s_and_b32 s29, s29, 31
    s_mul_i32 s29, s29, 20736
    s_add_u32 s29, s29, s27
    s_add_u32 s28, s29, 2304
    buffer_load_dwordx4 v3, s[12:15], s28 offen lds
    s_add_u32 m0, m0, 1024
    s_add_u32 s28, s29, 6912
    buffer_load_dwordx4 v3, s[12:15], s28 offen lds
    s_add_u32 m0, m0, 1024
    s_add_u32 s29, s36, 4
    s_and_b32 s29, s29, 31
    s_mul_i32 s29, s29, 20736
    s_add_u32 s29, s29, s27
    s_add_u32 s28, s29, 0
    buffer_load_dwordx4 v3, s[12:15], s28 offen lds
    s_add_u32 m0, m0, 1024
    s_add_u32 s28, s29, 4608
    buffer_load_dwordx4 v3, s[12:15], s28 offen lds
    s_add_u32 m0, m0, 1024
    s_add_u32 s29, s36, 5
    s_and_b32 s29, s29, 31
    s_mul_i32 s29, s29, 20736
    s_add_u32 s29, s29, s27
    s_add_u32 s28, s29, 2304
    buffer_load_dwordx4 v3, s[12:15], s28 offen lds
    s_add_u32 m0, m0, 1024
    s_add_u32 s28, s29, 6912
    buffer_load_dwordx4 v3, s[12:15], s28 offen lds
    s_add_u32 m0, m0, 1024
    s_add_u32 s29, s36, 6
    s_and_b32 s29, s29, 31
    s_mul_i32 s29, s29, 20736
    s_add_u32 s29, s29, s27
    s_add_u32 s28, s29, 0
    buffer_load_dwordx4 v3, s[12:15], s28 offen lds
    s_add_u32 m0, m0, 1024
    s_add_u32 s28, s29, 4608
    buffer_load_dwordx4 v3, s[12:15], s28 offen lds
    s_add_u32 m0, m0, 1024
    s_add_u32 s29, s36, 7
    s_and_b32 s29, s29, 31
    s_mul_i32 s29, s29, 20736
    s_add_u32 s29, s29, s27
    s_add_u32 s28, s29, 2304
    buffer_load_dwordx4 v3, s[12:15], s28 offen lds
    s_add_u32 m0, m0, 1024
    s_add_u32 s28, s29, 6912
    buffer_load_dwordx4 v3, s[12:15], s28 offen lds
    s_add_u32 m0, m0, 1024
    s_add_u32 s29, s36, 8
    s_and_b32 s29, s29, 31
    s_mul_i32 s29, s29, 20736
    s_add_u32 s29, s29, s27
    s_add_u32 s28, s29, 0
    buffer_load_dwordx4 v3, s[12:15], s28 offen lds
    s_add_u32 m0, m0, 1024
    s_add_u32 s28, s29, 4608
    buffer_load_dwordx4 v3, s[12:15], s28 offen lds
    s_add_u32 m0, m0, 1024
    s_add_u32 s29, s36, 9
    s_and_b32 s29, s29, 31
    s_mul_i32 s29, s29, 20736
    s_add_u32 s29, s29, s27
    s_add_u32 s28, s29, 2304
    buffer_load_dwordx4 v3, s[12:15], s28 offen lds
    s_add_u32 m0, m0, 1024
    s_add_u32 s28, s29, 6912
    buffer_load_dwordx4 v3, s[12:15], s28 offen lds
    s_add_u32 m0, m0, 1024
    s_add_u32 s29, s36, 10
    s_and_b32 s29, s29, 31
    s_mul_i32 s29, s29, 20736
    s_add_u32 s29, s29, s27
    s_add_u32 s28, s29, 0
    buffer_load_dwordx4 v3, s[12:15], s28 offen lds
    s_add_u32 m0, m0, 1024
    s_add_u32 s28, s29, 4608
    buffer_load_dwordx4 v3, s[12:15], s28 offen lds
    s_add_u32 m0, m0, 1024
    s_add_u32 s29, s36, 11
    s_and_b32 s29, s29, 31
    s_mul_i32 s29, s29, 20736
    s_add_u32 s29, s29, s27
    s_add_u32 s28, s29, 2304
    buffer_load_dwordx4 v3, s[12:15], s28 offen lds
    s_add_u32 m0, m0, 1024
    s_add_u32 s28, s29, 6912
    buffer_load_dwordx4 v3, s[12:15], s28 offen lds
    s_add_u32 m0, m0, 1024
    s_waitcnt vmcnt(12)
    s_barrier
    s_add_u32 s29, s36, 12
    s_and_b32 s29, s29, 31
    s_mul_i32 s29, s29, 20736
    s_add_u32 s29, s29, s27
    s_add_u32 s28, s29, 0
    buffer_load_dwordx4 v3, s[12:15], s28 offen lds
    s_add_u32 m0, m0, 1024
    s_add_u32 s28, s29, 4608
    buffer_load_dwordx4 v3, s[12:15], s28 offen lds
    s_add_u32 m0, m0, 1024
    s_add_u32 s29, s36, 13
    s_and_b32 s29, s29, 31
    s_mul_i32 s29, s29, 20736
    s_add_u32 s29, s29, s27
    s_add_u32 s28, s29, 2304
    buffer_load_dwordx4 v3, s[12:15], s28 offen lds
    s_add_u32 m0, m0, 1024
    s_add_u32 s28, s29, 6912
    buffer_load_dwordx4 v3, s[12:15], s28 offen lds
    s_add_u32 m0, m0, 1024
    s_add_u32 s29, s36, 14
    s_and_b32 s29, s29, 31
    s_mul_i32 s29, s29, 20736
    s_add_u32 s29, s29, s27
    s_add_u32 s28, s29, 0
    buffer_load_dwordx4 v3, s[12:15], s28 offen lds
    s_add_u32 m0, m0, 1024
    s_add_u32 s28, s29, 4608
    buffer_load_dwordx4 v3, s[12:15], s28 offen lds
    s_add_u32 m0, m0, 1024
    s_add_u32 s29, s36, 15
    s_and_b32 s29, s29, 31
    s_mul_i32 s29, s29, 20736
    s_add_u32 s29, s29, s27
    s_add_u32 s28, s29, 2304
    buffer_load_dwordx4 v3, s[12:15], s28 offen lds
    s_add_u32 m0, m0, 1024
    s_add_u32 s28, s29, 6912
    buffer_load_dwordx4 v3, s[12:15], s28 offen lds
    s_add_u32 m0, m0, 1024
    s_add_u32 s29, s36, 16
    s_and_b32 s29, s29, 31
    s_mul_i32 s29, s29, 20736
    s_add_u32 s29, s29, s27
    s_add_u32 s28, s29, 0
    buffer_load_dwordx4 v3, s[12:15], s28 offen lds
    s_add_u32 m0, m0, 1024
    s_add_u32 s28, s29, 4608
    buffer_load_dwordx4 v3, s[12:15], s28 offen lds
    s_add_u32 m0, m0, 1024
    s_add_u32 s29, s36, 17
    s_and_b32 s29, s29, 31
    s_mul_i32 s29, s29, 20736
    s_add_u32 s29, s29, s27
    s_add_u32 s28, s29, 2304
    buffer_load_dwordx4 v3, s[12:15], s28 offen lds
    s_add_u32 m0, m0, 1024
    s_add_u32 s28, s29, 6912
    buffer_load_dwordx4 v3, s[12:15], s28 offen lds
    s_add_u32 m0, m0, 1024
    s_waitcnt vmcnt(12)
    s_barrier
    s_add_u32 s29, s36, 18
    s_and_b32 s29, s29, 31
    s_mul_i32 s29, s29, 20736
    s_add_u32 s29, s29, s27
    s_add_u32 s28, s29, 0
    buffer_load_dwordx4 v3, s[12:15], s28 offen lds
    s_add_u32 m0, m0, 1024
    s_add_u32 s28, s29, 4608
    buffer_load_dwordx4 v3, s[12:15], s28 offen lds
    s_add_u32 m0, m0, 1024
    s_add_u32 s29, s36, 19
    s_and_b32 s29, s29, 31
    s_mul_i32 s29, s29, 20736
    s_add_u32 s29, s29, s27
    s_add_u32 s28, s29, 2304
    buffer_load_dwordx4 v3, s[12:15], s28 offen lds
    s_add_u32 m0, m0, 1024
    s_add_u32 s28, s29, 6912
    buffer_load_dwordx4 v3, s[12:15], s28 offen lds
    s_add_u32 m0, m0, 1024
    s_add_u32 s29, s36, 20
    s_and_b32 s29, s29, 31
    s_mul_i32 s29, s29, 20736
    s_add_u32 s29, s29, s27
    s_add_u32 s28, s29, 0
    buffer_load_dwordx4 v3, s[12:15], s28 offen lds
    s_add_u32 m0, m0, 1024
    s_add_u32 s28, s29, 4608
    buffer_load_dwordx4 v3, s[12:15], s28 offen lds
    s_add_u32 m0, m0, 1024
    s_add_u32 s29, s36, 21
    s_and_b32 s29, s29, 31
    s_mul_i32 s29, s29, 20736
    s_add_u32 s29, s29, s27
    s_add_u32 s28, s29, 2304
    buffer_load_dwordx4 v3, s[12:15], s28 offen lds
    s_add_u32 m0, m0, 1024
    s_add_u32 s28, s29, 6912
    buffer_load_dwordx4 v3, s[12:15], s28 offen lds
    s_add_u32 m0, m0, 1024
    s_add_u32 s29, s36, 22
    s_and_b32 s29, s29, 31
    s_mul_i32 s29, s29, 20736
    s_add_u32 s29, s29, s27
    s_add_u32 s28, s29, 0
    buffer_load_dwordx4 v3, s[12:15], s28 offen lds
    s_add_u32 m0, m0, 1024
    s_add_u32 s28, s29, 4608
    buffer_load_dwordx4 v3, s[12:15], s28 offen lds
    s_add_u32 m0, m0, 1024
    s_add_u32 s29, s36, 23
    s_and_b32 s29, s29, 31
    s_mul_i32 s29, s29, 20736
    s_add_u32 s29, s29, s27
    s_add_u32 s28, s29, 2304
    buffer_load_dwordx4 v3, s[12:15], s28 offen lds
    s_add_u32 m0, m0, 1024
    s_add_u32 s28, s29, 6912
    buffer_load_dwordx4 v3, s[12:15], s28 offen lds
    s_add_u32 m0, m0, 1024
    s_waitcnt vmcnt(12)
    s_barrier
    s_add_u32 s29, s36, 24
    s_and_b32 s29, s29, 31
    s_mul_i32 s29, s29, 20736
    s_add_u32 s29, s29, s27
    s_add_u32 s28, s29, 0
    buffer_load_dwordx4 v3, s[12:15], s28 offen lds
    s_add_u32 m0, m0, 1024
    s_add_u32 s28, s29, 4608
    buffer_load_dwordx4 v3, s[12:15], s28 offen lds
    s_add_u32 m0, m0, 1024
    s_add_u32 s29, s36, 25
    s_and_b32 s29, s29, 31
    s_mul_i32 s29, s29, 20736
    s_add_u32 s29, s29, s27
    s_add_u32 s28, s29, 2304
    buffer_load_dwordx4 v3, s[12:15], s28 offen lds
    s_add_u32 m0, m0, 1024
    s_add_u32 s28, s29, 6912
    buffer_load_dwordx4 v3, s[12:15], s28 offen lds
    s_add_u32 m0, m0, 1024
    s_add_u32 s29, s36, 26
    s_and_b32 s29, s29, 31
    s_mul_i32 s29, s29, 20736
    s_add_u32 s29, s29, s27
    s_add_u32 s28, s29, 0
    buffer_load_dwordx4 v3, s[12:15], s28 offen lds
    s_add_u32 m0, m0, 1024
    s_add_u32 s28, s29, 4608
    buffer_load_dwordx4 v3, s[12:15], s28 offen lds
    s_add_u32 m0, m0, 1024
    s_add_u32 s29, s36, 27
    s_and_b32 s29, s29, 31
    s_mul_i32 s29, s29, 20736
    s_add_u32 s29, s29, s27
    s_add_u32 s28, s29, 2304
    buffer_load_dwordx4 v3, s[12:15], s28 offen lds
    s_add_u32 m0, m0, 1024
    s_add_u32 s28, s29, 6912
    buffer_load_dwordx4 v3, s[12:15], s28 offen lds
    s_add_u32 m0, m0, 1024
    s_add_u32 s29, s36, 28
    s_and_b32 s29, s29, 31
    s_mul_i32 s29, s29, 20736
    s_add_u32 s29, s29, s27
    s_add_u32 s28, s29, 0
    buffer_load_dwordx4 v3, s[12:15], s28 offen lds
    s_add_u32 m0, m0, 1024
    s_add_u32 s28, s29, 4608
    buffer_load_dwordx4 v3, s[12:15], s28 offen lds
    s_add_u32 m0, m0, 1024
    s_add_u32 s29, s36, 29
    s_and_b32 s29, s29, 31
    s_mul_i32 s29, s29, 20736
    s_add_u32 s29, s29, s27
    s_add_u32 s28, s29, 2304
    buffer_load_dwordx4 v3, s[12:15], s28 offen lds
    s_add_u32 m0, m0, 1024
    s_add_u32 s28, s29, 6912
    buffer_load_dwordx4 v3, s[12:15], s28 offen lds
    s_add_u32 m0, m0, 1024
    s_waitcnt vmcnt(12)
    s_barrier
    s_add_u32 s29, s36, 30
    s_and_b32 s29, s29, 31
    s_mul_i32 s29, s29, 20736
    s_add_u32 s29, s29, s27
    s_add_u32 s28, s29, 0
    buffer_load_dwordx4 v3, s[12:15], s28 offen lds
    s_add_u32 m0, m0, 1024
    s_add_u32 s28, s29, 4608
    buffer_load_dwordx4 v3, s[12:15], s28 offen lds
    s_add_u32 m0, m0, 1024
    s_add_u32 s29, s36, 31
    s_and_b32 s29, s29, 31
    s_mul_i32 s29, s29, 20736
    s_add_u32 s29, s29, s27
    s_add_u32 s28, s29, 2304
    buffer_load_dwordx4 v3, s[12:15], s28 offen lds
    s_add_u32 m0, m0, 1024
    s_add_u32 s28, s29, 6912
    buffer_load_dwordx4 v3, s[12:15], s28 offen lds
    s_add_u32 m0, m0, 1024
    s_add_u32 s28, s27, 0
    buffer_load_dwordx4 v4, s[12:15], s28 offen lds
    s_add_u32 m0, m0, 1024
    s_add_u32 s28, s27, 82944
    buffer_load_dwordx4 v4, s[12:15], s28 offen lds
    s_add_u32 m0, m0, 1024
    s_add_u32 s28, s27, 165888
    buffer_load_dwordx4 v4, s[12:15], s28 offen lds
    s_add_u32 m0, m0, 1024
    s_add_u32 s28, s27, 248832
    buffer_load_dwordx4 v4, s[12:15], s28 offen lds
    s_add_u32 m0, m0, 1024
    s_add_u32 s28, s27, 331776
    buffer_load_dwordx4 v4, s[12:15], s28 offen lds
    s_add_u32 m0, m0, 1024
    s_add_u32 s28, s27, 414720
    buffer_load_dwordx4 v4, s[12:15], s28 offen lds
    s_add_u32 m0, m0, 1024
    s_add_u32 s28, s27, 497664
    buffer_load_dwordx4 v4, s[12:15], s28 offen lds
    s_add_u32 m0, m0, 1024
    s_add_u32 s28, s27, 580608
    buffer_load_dwordx4 v4, s[12:15], s28 offen lds
    s_add_u32 m0, m0, 1024
    s_waitcnt vmcnt(12)
    s_barrier
    s_waitcnt vmcnt(0)
    s_barrier
    s_barrier
    s_barrier
    s_endpgm
k3_out_kernel_comp:
    s_cmp_ge_u32 s22, 3
    s_cselect_b32 s23, 1, 0
    s_mul_i32 s26, s23, 3
    s_sub_u32 s24, s22, s26
    s_mul_i32 s25, s20, 3
    s_add_u32 s25, s25, s24
    s_min_u32 s29, s25, 63
    v_lshlrev_b32 v2, 4, v1
    s_waitcnt lgkmcnt(0)
    s_mov_b32 s8, s4
    s_and_b32 s9, s5, 0xffff
    s_mov_b32 s10, 23068672
    s_mov_b32 s11, 0x00020000
    s_mov_b32 s16, s34
    s_and_b32 s17, s35, 0xffff
    s_mov_b32 s18, 2359296
    s_mov_b32 s19, 0x00020000
    s_lshl_b32 s26, s23, 6
    s_add_u32 s26, s26, s29
    s_lshl_b32 s27, s26, 15
    s_add_u32 s27, s27, 16777216
    s_lshl_b32 s36, s21, 2
    s_mov_b32 s37, s27
    v_and_b32 v8, 31, v1
    v_lshlrev_b32 v7, 2, v8
    v_lshrrev_b32 v9, 5, v1
    v_lshl_add_u32 v7, v9, 9, v7
    s_lshl_b32 s38, s26, 12
    s_add_u32 s38, s38, 20971520
    s_add_u32 s39, s36, 0
    s_and_b32 s39, s39, 31
    s_lshl_b32 s39, s39, 10
    s_add_u32 s39, s39, s37
    buffer_load_dwordx4 v[64:67], v2, s[8:11], s39 offen
    s_add_u32 s39, s36, 1
    s_and_b32 s39, s39, 31
    s_lshl_b32 s39, s39, 10
    s_add_u32 s39, s39, s37
    buffer_load_dwordx4 v[68:71], v2, s[8:11], s39 offen
    s_add_u32 s39, s36, 2
    s_and_b32 s39, s39, 31
    s_lshl_b32 s39, s39, 10
    s_add_u32 s39, s39, s37
    buffer_load_dwordx4 v[72:75], v2, s[8:11], s39 offen
    s_add_u32 s39, s36, 3
    s_and_b32 s39, s39, 31
    s_lshl_b32 s39, s39, 10
    s_add_u32 s39, s39, s37
    buffer_load_dwordx4 v[76:79], v2, s[8:11], s39 offen
    s_add_u32 s39, s36, 4
    s_and_b32 s39, s39, 31
    s_lshl_b32 s39, s39, 10
    s_add_u32 s39, s39, s37
    buffer_load_dwordx4 v[80:83], v2, s[8:11], s39 offen
    s_add_u32 s39, s36, 5
    s_and_b32 s39, s39, 31
    s_lshl_b32 s39, s39, 10
    s_add_u32 s39, s39, s37
    buffer_load_dwordx4 v[84:87], v2, s[8:11], s39 offen
    s_add_u32 s39, s36, 6
    s_and_b32 s39, s39, 31
    s_lshl_b32 s39, s39, 10
    s_add_u32 s39, s39, s37
    buffer_load_dwordx4 v[88:91], v2, s[8:11], s39 offen
    s_add_u32 s39, s36, 7
    s_and_b32 s39, s39, 31
    s_lshl_b32 s39, s39, 10
    s_add_u32 s39, s39, s37
    buffer_load_dwordx4 v[92:95], v2, s[8:11], s39 offen
    s_add_u32 s39, s36, 8
    s_and_b32 s39, s39, 31
    s_lshl_b32 s39, s39, 10
    s_add_u32 s39, s39, s37
    buffer_load_dwordx4 v[96:99], v2, s[8:11], s39 offen
    s_add_u32 s39, s36, 9
    s_and_b32 s39, s39, 31
    s_lshl_b32 s39, s39, 10
    s_add_u32 s39, s39, s37
    buffer_load_dwordx4 v[100:103], v2, s[8:11], s39 offen
    s_add_u32 s39, s36, 10
    s_and_b32 s39, s39, 31
    s_lshl_b32 s39, s39, 10
    s_add_u32 s39, s39, s37
    buffer_load_dwordx4 v[104:107], v2, s[8:11], s39 offen
    s_add_u32 s39, s36, 11
    s_and_b32 s39, s39, 31
    s_lshl_b32 s39, s39, 10
    s_add_u32 s39, s39, s37
    buffer_load_dwordx4 v[108:111], v2, s[8:11], s39 offen
    v_bfe_u32 v10, v1, 2, 2
    v_lshl_add_u32 v11, v9, 3, v10
    v_lshlrev_b32 v11, 7, v11
    v_bfe_u32 v12, v1, 4, 1
    v_lshlrev_b32 v12, 5, v12
    v_and_b32 v13, 1, v1
    v_lshlrev_b32 v13, 1, v13
    v_bfe_u32 v14, v1, 1, 1
    v_or_b32 v13, v13, v14
    v_lshl_add_u32 v12, v13, 3, v12
    v_lshrrev_b32 v10, 1, v10
    v_lshlrev_b32 v10, 6, v10
    v_xor_b32 v12, v12, v10
    s_mul_i32 s26, s23, 73728
    v_add3_u32 v5, v11, v12, s26
    v_xor_b32 v6, 64, v5
    v_mov_b32 v32, 0
    v_mov_b32 v33, 0
    v_mov_b32 v34, 0
    v_mov_b32 v35, 0
    v_mov_b32 v36, 0
    v_mov_b32 v37, 0
    v_mov_b32 v38, 0
    v_mov_b32 v39, 0
    v_mov_b32 v40, 0
    v_mov_b32 v41, 0
    v_mov_b32 v42, 0
    v_mov_b32 v43, 0
    v_mov_b32 v44, 0
    v_mov_b32 v45, 0
    v_mov_b32 v46, 0
    v_mov_b32 v47, 0
    v_mov_b32 v48, 0
    v_mov_b32 v49, 0
    v_mov_b32 v50, 0
    v_mov_b32 v51, 0
    v_mov_b32 v52, 0
    v_mov_b32 v53, 0
    v_mov_b32 v54, 0
    v_mov_b32 v55, 0
    v_mov_b32 v56, 0
    v_mov_b32 v57, 0
    v_mov_b32 v58, 0
    v_mov_b32 v59, 0
    v_mov_b32 v60, 0
    v_mov_b32 v61, 0
    v_mov_b32 v62, 0
    v_mov_b32 v63, 0
    s_barrier
    ds_read_b64_tr_b16 v[16:17], v5 offset:0
    ds_read_b64_tr_b16 v[18:19], v5 offset:512
    ds_read_b64_tr_b16 v[20:21], v6 offset:0
    ds_read_b64_tr_b16 v[22:23], v6 offset:512
    s_waitcnt vmcnt(11)
    s_waitcnt lgkmcnt(2)
    v_mfma_f32_32x32x16_bf16 v[32:47], v[16:19], v[64:67], v[32:47]
    ds_read_b64_tr_b16 v[24:25], v5 offset:2048
    ds_read_b64_tr_b16 v[26:27], v5 offset:2560
    s_waitcnt lgkmcnt(2)
    v_mfma_f32_32x32x16_bf16 v[48:63], v[20:23], v[64:67], v[48:63]
    ds_read_b64_tr_b16 v[28:29], v6 offset:2048
    ds_read_b64_tr_b16 v[30:31], v6 offset:2560
    s_add_u32 s39, s36, 12
    s_and_b32 s39, s39, 31
    s_lshl_b32 s39, s39, 10
    s_add_u32 s39, s39, s37
    buffer_load_dwordx4 v[112:115], v2, s[8:11], s39 offen
    s_waitcnt vmcnt(11)
    s_waitcnt lgkmcnt(2)
    v_mfma_f32_32x32x16_bf16 v[32:47], v[24:27], v[68:71], v[32:47]
    ds_read_b64_tr_b16 v[16:17], v5 offset:4096
    ds_read_b64_tr_b16 v[18:19], v5 offset:4608
    s_waitcnt lgkmcnt(2)
    v_mfma_f32_32x32x16_bf16 v[48:63], v[28:31], v[68:71], v[48:63]
    ds_read_b64_tr_b16 v[20:21], v6 offset:4096
    ds_read_b64_tr_b16 v[22:23], v6 offset:4608
    s_add_u32 s39, s36, 13
    s_and_b32 s39, s39, 31
    s_lshl_b32 s39, s39, 10
    s_add_u32 s39, s39, s37
    buffer_load_dwordx4 v[116:119], v2, s[8:11], s39 offen
    s_waitcnt vmcnt(11)
    s_waitcnt lgkmcnt(2)
    v_mfma_f32_32x32x16_bf16 v[32:47], v[16:19], v[72:75], v[32:47]
    ds_read_b64_tr_b16 v[24:25], v5 offset:6144
    ds_read_b64_tr_b16 v[26:27], v5 offset:6656
    s_waitcnt lgkmcnt(2)
    v_mfma_f32_32x32x16_bf16 v[48:63], v[20:23], v[72:75], v[48:63]
    ds_read_b64_tr_b16 v[28:29], v6 offset:6144
    ds_read_b64_tr_b16 v[30:31], v6 offset:6656
    s_add_u32 s39, s36, 14
    s_and_b32 s39, s39, 31
    s_lshl_b32 s39, s39, 10
    s_add_u32 s39, s39, s37
    buffer_load_dwordx4 v[120:123], v2, s[8:11], s39 offen
    s_waitcnt vmcnt(11)
    s_waitcnt lgkmcnt(2)
    v_mfma_f32_32x32x16_bf16 v[32:47], v[24:27], v[76:79], v[32:47]
    ds_read_b64_tr_b16 v[16:17], v5 offset:8192
    ds_read_b64_tr_b16 v[18:19], v5 offset:8704
    s_waitcnt lgkmcnt(2)
    v_mfma_f32_32x32x16_bf16 v[48:63], v[28:31], v[76:79], v[48:63]
    ds_read_b64_tr_b16 v[20:21], v6 offset:8192
    ds_read_b64_tr_b16 v[22:23], v6 offset:8704
    s_add_u32 s39, s36, 15
    s_and_b32 s39, s39, 31
    s_lshl_b32 s39, s39, 10
    s_add_u32 s39, s39, s37
    buffer_load_dwordx4 v[124:127], v2, s[8:11], s39 offen
    s_waitcnt vmcnt(11)
    s_waitcnt lgkmcnt(2)
    v_mfma_f32_32x32x16_bf16 v[32:47], v[16:19], v[80:83], v[32:47]
    ds_read_b64_tr_b16 v[24:25], v5 offset:10240
    ds_read_b64_tr_b16 v[26:27], v5 offset:10752
    s_waitcnt lgkmcnt(2)
    v_mfma_f32_32x32x16_bf16 v[48:63], v[20:23], v[80:83], v[48:63]
    ds_read_b64_tr_b16 v[28:29], v6 offset:10240
    ds_read_b64_tr_b16 v[30:31], v6 offset:10752
    s_add_u32 s39, s36, 16
    s_and_b32 s39, s39, 31
    s_lshl_b32 s39, s39, 10
    s_add_u32 s39, s39, s37
    buffer_load_dwordx4 v[128:131], v2, s[8:11], s39 offen
    s_waitcnt vmcnt(11)
    s_waitcnt lgkmcnt(2)
    v_mfma_f32_32x32x16_bf16 v[32:47], v[24:27], v[84:87], v[32:47]
    s_waitcnt lgkmcnt(0)
    v_mfma_f32_32x32x16_bf16 v[48:63], v[28:31], v[84:87], v[48:63]
    s_add_u32 s39, s36, 17
    s_and_b32 s39, s39, 31
    s_lshl_b32 s39, s39, 10
    s_add_u32 s39, s39, s37
    buffer_load_dwordx4 v[132:135], v2, s[8:11], s39 offen
    v_add_u32 v5, 12288, v5
    v_add_u32 v6, 12288, v6
    s_barrier
    ds_read_b64_tr_b16 v[16:17], v5 offset:0
    ds_read_b64_tr_b16 v[18:19], v5 offset:512
    ds_read_b64_tr_b16 v[20:21], v6 offset:0
    ds_read_b64_tr_b16 v[22:23], v6 offset:512
    s_waitcnt vmcnt(11)
    s_waitcnt lgkmcnt(2)
    v_mfma_f32_32x32x16_bf16 v[32:47], v[16:19], v[88:91], v[32:47]
    ds_read_b64_tr_b16 v[24:25], v5 offset:2048
    ds_read_b64_tr_b16 v[26:27], v5 offset:2560
    s_waitcnt lgkmcnt(2)
    v_mfma_f32_32x32x16_bf16 v[48:63], v[20:23], v[88:91], v[48:63]
    ds_read_b64_tr_b16 v[28:29], v6 offset:2048
    ds_read_b64_tr_b16 v[30:31], v6 offset:2560
    s_add_u32 s39, s36, 18
    s_and_b32 s39, s39, 31
    s_lshl_b32 s39, s39, 10
    s_add_u32 s39, s39, s37
    buffer_load_dwordx4 v[136:139], v2, s[8:11], s39 offen
    s_waitcnt vmcnt(11)
    s_waitcnt lgkmcnt(2)
    v_mfma_f32_32x32x16_bf16 v[32:47], v[24:27], v[92:95], v[32:47]
    ds_read_b64_tr_b16 v[16:17], v5 offset:4096
    ds_read_b64_tr_b16 v[18:19], v5 offset:4608
    s_waitcnt lgkmcnt(2)
    v_mfma_f32_32x32x16_bf16 v[48:63], v[28:31], v[92:95], v[48:63]
    ds_read_b64_tr_b16 v[20:21], v6 offset:4096
    ds_read_b64_tr_b16 v[22:23], v6 offset:4608
    s_add_u32 s39, s36, 19
    s_and_b32 s39, s39, 31
    s_lshl_b32 s39, s39, 10
    s_add_u32 s39, s39, s37
    buffer_load_dwordx4 v[140:143], v2, s[8:11], s39 offen
    s_waitcnt vmcnt(11)
    s_waitcnt lgkmcnt(2)
    v_mfma_f32_32x32x16_bf16 v[32:47], v[16:19], v[96:99], v[32:47]
    ds_read_b64_tr_b16 v[24:25], v5 offset:6144
    ds_read_b64_tr_b16 v[26:27], v5 offset:6656
    s_waitcnt lgkmcnt(2)
    v_mfma_f32_32x32x16_bf16 v[48:63], v[20:23], v[96:99], v[48:63]
    ds_read_b64_tr_b16 v[28:29], v6 offset:6144
    ds_read_b64_tr_b16 v[30:31], v6 offset:6656
    s_add_u32 s39, s36, 20
    s_and_b32 s39, s39, 31
    s_lshl_b32 s39, s39, 10
    s_add_u32 s39, s39, s37
    buffer_load_dwordx4 v[144:147], v2, s[8:11], s39 offen
    s_waitcnt vmcnt(11)
    s_waitcnt lgkmcnt(2)
    v_mfma_f32_32x32x16_bf16 v[32:47], v[24:27], v[100:103], v[32:47]
    ds_read_b64_tr_b16 v[16:17], v5 offset:8192
    ds_read_b64_tr_b16 v[18:19], v5 offset:8704
    s_waitcnt lgkmcnt(2)
    v_mfma_f32_32x32x16_bf16 v[48:63], v[28:31], v[100:103], v[48:63]
    ds_read_b64_tr_b16 v[20:21], v6 offset:8192
    ds_read_b64_tr_b16 v[22:23], v6 offset:8704
    s_add_u32 s39, s36, 21
    s_and_b32 s39, s39, 31
    s_lshl_b32 s39, s39, 10
    s_add_u32 s39, s39, s37
    buffer_load_dwordx4 v[148:151], v2, s[8:11], s39 offen
    s_waitcnt vmcnt(11)
    s_waitcnt lgkmcnt(2)
    v_mfma_f32_32x32x16_bf16 v[32:47], v[16:19], v[104:107], v[32:47]
    ds_read_b64_tr_b16 v[24:25], v5 offset:10240
    ds_read_b64_tr_b16 v[26:27], v5 offset:10752
    s_waitcnt lgkmcnt(2)
    v_mfma_f32_32x32x16_bf16 v[48:63], v[20:23], v[104:107], v[48:63]
    ds_read_b64_tr_b16 v[28:29], v6 offset:10240
    ds_read_b64_tr_b16 v[30:31], v6 offset:10752
    s_add_u32 s39, s36, 22
    s_and_b32 s39, s39, 31
    s_lshl_b32 s39, s39, 10
    s_add_u32 s39, s39, s37
    buffer_load_dwordx4 v[152:155], v2, s[8:11], s39 offen
    s_waitcnt vmcnt(11)
    s_waitcnt lgkmcnt(2)
    v_mfma_f32_32x32x16_bf16 v[32:47], v[24:27], v[108:111], v[32:47]
    s_waitcnt lgkmcnt(0)
    v_mfma_f32_32x32x16_bf16 v[48:63], v[28:31], v[108:111], v[48:63]
    s_add_u32 s39, s36, 23
    s_and_b32 s39, s39, 31
    s_lshl_b32 s39, s39, 10
    s_add_u32 s39, s39, s37
    buffer_load_dwordx4 v[156:159], v2, s[8:11], s39 offen
    v_add_u32 v5, 12288, v5
    v_add_u32 v6, 12288, v6
    s_barrier
    ds_read_b64_tr_b16 v[16:17], v5 offset:0
    ds_read_b64_tr_b16 v[18:19], v5 offset:512
    ds_read_b64_tr_b16 v[20:21], v6 offset:0
    ds_read_b64_tr_b16 v[22:23], v6 offset:512
    s_waitcnt vmcnt(11)
    s_waitcnt lgkmcnt(2)
    v_mfma_f32_32x32x16_bf16 v[32:47], v[16:19], v[112:115], v[32:47]
    ds_read_b64_tr_b16 v[24:25], v5 offset:2048
    ds_read_b64_tr_b16 v[26:27], v5 offset:2560
    s_waitcnt lgkmcnt(2)
    v_mfma_f32_32x32x16_bf16 v[48:63], v[20:23], v[112:115], v[48:63]
    ds_read_b64_tr_b16 v[28:29], v6 offset:2048
    ds_read_b64_tr_b16 v[30:31], v6 offset:2560
    s_add_u32 s39, s36, 24
    s_and_b32 s39, s39, 31
    s_lshl_b32 s39, s39, 10
    s_add_u32 s39, s39, s37
    buffer_load_dwordx4 v[160:163], v2, s[8:11], s39 offen
    s_waitcnt vmcnt(11)
    s_waitcnt lgkmcnt(2)
    v_mfma_f32_32x32x16_bf16 v[32:47], v[24:27], v[116:119], v[32:47]
    ds_read_b64_tr_b16 v[16:17], v5 offset:4096
    ds_read_b64_tr_b16 v[18:19], v5 offset:4608
    s_waitcnt lgkmcnt(2)
    v_mfma_f32_32x32x16_bf16 v[48:63], v[28:31], v[116:119], v[48:63]
    ds_read_b64_tr_b16 v[20:21], v6 offset:4096
    ds_read_b64_tr_b16 v[22:23], v6 offset:4608
    s_add_u32 s39, s36, 25
    s_and_b32 s39, s39, 31
    s_lshl_b32 s39, s39, 10
    s_add_u32 s39, s39, s37
    buffer_load_dwordx4 v[164:167], v2, s[8:11], s39 offen
    s_waitcnt vmcnt(11)
    s_waitcnt lgkmcnt(2)
    v_mfma_f32_32x32x16_bf16 v[32:47], v[16:19], v[120:123], v[32:47]
    ds_read_b64_tr_b16 v[24:25], v5 offset:6144
    ds_read_b64_tr_b16 v[26:27], v5 offset:6656
    s_waitcnt lgkmcnt(2)
    v_mfma_f32_32x32x16_bf16 v[48:63], v[20:23], v[120:123], v[48:63]
    ds_read_b64_tr_b16 v[28:29], v6 offset:6144
    ds_read_b64_tr_b16 v[30:31], v6 offset:6656
    s_add_u32 s39, s36, 26
    s_and_b32 s39, s39, 31
    s_lshl_b32 s39, s39, 10
    s_add_u32 s39, s39, s37
    buffer_load_dwordx4 v[168:171], v2, s[8:11], s39 offen
    s_waitcnt vmcnt(11)
    s_waitcnt lgkmcnt(2)
    v_mfma_f32_32x32x16_bf16 v[32:47], v[24:27], v[124:127], v[32:47]
    ds_read_b64_tr_b16 v[16:17], v5 offset:8192
    ds_read_b64_tr_b16 v[18:19], v5 offset:8704
    s_waitcnt lgkmcnt(2)
    v_mfma_f32_32x32x16_bf16 v[48:63], v[28:31], v[124:127], v[48:63]
    ds_read_b64_tr_b16 v[20:21], v6 offset:8192
    ds_read_b64_tr_b16 v[22:23], v6 offset:8704
    s_add_u32 s39, s36, 27
    s_and_b32 s39, s39, 31
    s_lshl_b32 s39, s39, 10
    s_add_u32 s39, s39, s37
    buffer_load_dwordx4 v[172:175], v2, s[8:11], s39 offen
    s_waitcnt vmcnt(11)
    s_waitcnt lgkmcnt(2)
    v_mfma_f32_32x32x16_bf16 v[32:47], v[16:19], v[128:131], v[32:47]
    ds_read_b64_tr_b16 v[24:25], v5 offset:10240
    ds_read_b64_tr_b16 v[26:27], v5 offset:10752
    s_waitcnt lgkmcnt(2)
    v_mfma_f32_32x32x16_bf16 v[48:63], v[20:23], v[128:131], v[48:63]
    ds_read_b64_tr_b16 v[28:29], v6 offset:10240
    ds_read_b64_tr_b16 v[30:31], v6 offset:10752
    s_add_u32 s39, s36, 28
    s_and_b32 s39, s39, 31
    s_lshl_b32 s39, s39, 10
    s_add_u32 s39, s39, s37
    buffer_load_dwordx4 v[176:179], v2, s[8:11], s39 offen
    s_waitcnt vmcnt(11)
    s_waitcnt lgkmcnt(2)
    v_mfma_f32_32x32x16_bf16 v[32:47], v[24:27], v[132:135], v[32:47]
    s_waitcnt lgkmcnt(0)
    v_mfma_f32_32x32x16_bf16 v[48:63], v[28:31], v[132:135], v[48:63]
    s_add_u32 s39, s36, 29
    s_and_b32 s39, s39, 31
    s_lshl_b32 s39, s39, 10
    s_add_u32 s39, s39, s37
    buffer_load_dwordx4 v[180:183], v2, s[8:11], s39 offen
    v_add_u32 v5, 12288, v5
    v_add_u32 v6, 12288, v6
    s_barrier
    ds_read_b64_tr_b16 v[16:17], v5 offset:0
    ds_read_b64_tr_b16 v[18:19], v5 offset:512
    ds_read_b64_tr_b16 v[20:21], v6 offset:0
    ds_read_b64_tr_b16 v[22:23], v6 offset:512
    s_waitcnt vmcnt(11)
    s_waitcnt lgkmcnt(2)
    v_mfma_f32_32x32x16_bf16 v[32:47], v[16:19], v[136:139], v[32:47]
    ds_read_b64_tr_b16 v[24:25], v5 offset:2048
    ds_read_b64_tr_b16 v[26:27], v5 offset:2560
    s_waitcnt lgkmcnt(2)
    v_mfma_f32_32x32x16_bf16 v[48:63], v[20:23], v[136:139], v[48:63]
    ds_read_b64_tr_b16 v[28:29], v6 offset:2048
    ds_read_b64_tr_b16 v[30:31], v6 offset:2560
    s_add_u32 s39, s36, 30
    s_and_b32 s39, s39, 31
    s_lshl_b32 s39, s39, 10
    s_add_u32 s39, s39, s37
    buffer_load_dwordx4 v[184:187], v2, s[8:11], s39 offen
    s_add_u32 s39, s36, 31
    s_and_b32 s39, s39, 31
    s_lshl_b32 s39, s39, 10
    s_add_u32 s39, s39, s37
    buffer_load_dwordx4 v[188:191], v2, s[8:11], s39 offen
    buffer_load_dword v192, v7, s[8:11], s38 offen offset:0
    s_waitcnt vmcnt(13)
    s_waitcnt lgkmcnt(2)
    v_mfma_f32_32x32x16_bf16 v[32:47], v[24:27], v[140:143], v[32:47]
    ds_read_b64_tr_b16 v[16:17], v5 offset:4096
    ds_read_b64_tr_b16 v[18:19], v5 offset:4608
    s_waitcnt lgkmcnt(2)
    v_mfma_f32_32x32x16_bf16 v[48:63], v[28:31], v[140:143], v[48:63]
    ds_read_b64_tr_b16 v[20:21], v6 offset:4096
    ds_read_b64_tr_b16 v[22:23], v6 offset:4608
    buffer_load_dword v193, v7, s[8:11], s38 offen offset:128
    buffer_load_dword v194, v7, s[8:11], s38 offen offset:256
    buffer_load_dword v195, v7, s[8:11], s38 offen offset:384
    s_waitcnt vmcnt(15)
    s_waitcnt lgkmcnt(2)
    v_mfma_f32_32x32x16_bf16 v[32:47], v[16:19], v[144:147], v[32:47]
    ds_read_b64_tr_b16 v[24:25], v5 offset:6144
    ds_read_b64_tr_b16 v[26:27], v5 offset:6656
    s_waitcnt lgkmcnt(2)
    v_mfma_f32_32x32x16_bf16 v[48:63], v[20:23], v[144:147], v[48:63]
    ds_read_b64_tr_b16 v[28:29], v6 offset:6144
    ds_read_b64_tr_b16 v[30:31], v6 offset:6656
    buffer_load_dword v196, v7, s[8:11], s38 offen offset:1024
    buffer_load_dword v197, v7, s[8:11], s38 offen offset:1152
    buffer_load_dword v198, v7, s[8:11], s38 offen offset:1280
    s_waitcnt vmcnt(17)
    s_waitcnt lgkmcnt(2)
    v_mfma_f32_32x32x16_bf16 v[32:47], v[24:27], v[148:151], v[32:47]
    ds_read_b64_tr_b16 v[16:17], v5 offset:8192
    ds_read_b64_tr_b16 v[18:19], v5 offset:8704
    s_waitcnt lgkmcnt(2)
    v_mfma_f32_32x32x16_bf16 v[48:63], v[28:31], v[148:151], v[48:63]
    ds_read_b64_tr_b16 v[20:21], v6 offset:8192
    ds_read_b64_tr_b16 v[22:23], v6 offset:8704
    buffer_load_dword v199, v7, s[8:11], s38 offen offset:1408
    buffer_load_dword v200, v7, s[8:11], s38 offen offset:2048
    buffer_load_dword v201, v7, s[8:11], s38 offen offset:2176
    s_waitcnt vmcnt(19)
    s_waitcnt lgkmcnt(2)
    v_mfma_f32_32x32x16_bf16 v[32:47], v[16:19], v[152:155], v[32:47]
    ds_read_b64_tr_b16 v[24:25], v5 offset:10240
    ds_read_b64_tr_b16 v[26:27], v5 offset:10752
    s_waitcnt lgkmcnt(2)
    v_mfma_f32_32x32x16_bf16 v[48:63], v[20:23], v[152:155], v[48:63]
    ds_read_b64_tr_b16 v[28:29], v6 offset:10240
    ds_read_b64_tr_b16 v[30:31], v6 offset:10752
    buffer_load_dword v202, v7, s[8:11], s38 offen offset:2304
    buffer_load_dword v203, v7, s[8:11], s38 offen offset:2432
    buffer_load_dword v204, v7, s[8:11], s38 offen offset:3072
    s_waitcnt vmcnt(21)
    s_waitcnt lgkmcnt(2)
    v_mfma_f32_32x32x16_bf16 v[32:47], v[24:27], v[156:159], v[32:47]
    s_waitcnt lgkmcnt(0)
    v_mfma_f32_32x32x16_bf16 v[48:63], v[28:31], v[156:159], v[48:63]
    buffer_load_dword v205, v7, s[8:11], s38 offen offset:3200
    buffer_load_dword v206, v7, s[8:11], s38 offen offset:3328
    buffer_load_dword v207, v7, s[8:11], s38 offen offset:3456
    v_add_u32 v5, 12288, v5
    v_add_u32 v6, 12288, v6
    s_barrier
    ds_read_b64_tr_b16 v[16:17], v5 offset:0
    ds_read_b64_tr_b16 v[18:19], v5 offset:512
    ds_read_b64_tr_b16 v[20:21], v6 offset:0
    ds_read_b64_tr_b16 v[22:23], v6 offset:512
    s_waitcnt vmcnt(23)
    s_waitcnt lgkmcnt(2)
    v_mfma_f32_32x32x16_bf16 v[32:47], v[16:19], v[160:163], v[32:47]
    ds_read_b64_tr_b16 v[24:25], v5 offset:2048
    ds_read_b64_tr_b16 v[26:27], v5 offset:2560
    s_waitcnt lgkmcnt(2)
    v_mfma_f32_32x32x16_bf16 v[48:63], v[20:23], v[160:163], v[48:63]
    ds_read_b64_tr_b16 v[28:29], v6 offset:2048
    ds_read_b64_tr_b16 v[30:31], v6 offset:2560
    s_waitcnt vmcnt(22)
    s_waitcnt lgkmcnt(2)
    v_mfma_f32_32x32x16_bf16 v[32:47], v[24:27], v[164:167], v[32:47]
    ds_read_b64_tr_b16 v[16:17], v5 offset:4096
    ds_read_b64_tr_b16 v[18:19], v5 offset:4608
    s_waitcnt lgkmcnt(2)
    v_mfma_f32_32x32x16_bf16 v[48:63], v[28:31], v[164:167], v[48:63]
    ds_read_b64_tr_b16 v[20:21], v6 offset:4096
    ds_read_b64_tr_b16 v[22:23], v6 offset:4608
    s_waitcnt vmcnt(21)
    s_waitcnt lgkmcnt(2)
    v_mfma_f32_32x32x16_bf16 v[32:47], v[16:19], v[168:171], v[32:47]
    ds_read_b64_tr_b16 v[24:25], v5 offset:6144
    ds_read_b64_tr_b16 v[26:27], v5 offset:6656
    s_waitcnt lgkmcnt(2)
    v_mfma_f32_32x32x16_bf16 v[48:63], v[20:23], v[168:171], v[48:63]
    ds_read_b64_tr_b16 v[28:29], v6 offset:6144
    ds_read_b64_tr_b16 v[30:31], v6 offset:6656
    s_waitcnt vmcnt(20)
    s_waitcnt lgkmcnt(2)
    v_mfma_f32_32x32x16_bf16 v[32:47], v[24:27], v[172:175], v[32:47]
    ds_read_b64_tr_b16 v[16:17], v5 offset:8192
    ds_read_b64_tr_b16 v[18:19], v5 offset:8704
    s_waitcnt lgkmcnt(2)
    v_mfma_f32_32x32x16_bf16 v[48:63], v[28:31], v[172:175], v[48:63]
    ds_read_b64_tr_b16 v[20:21], v6 offset:8192
    ds_read_b64_tr_b16 v[22:23], v6 offset:8704
    s_waitcnt vmcnt(19)
    s_waitcnt lgkmcnt(2)
    v_mfma_f32_32x32x16_bf16 v[32:47], v[16:19], v[176:179], v[32:47]
    ds_read_b64_tr_b16 v[24:25], v5 offset:10240
    ds_read_b64_tr_b16 v[26:27], v5 offset:10752
    s_waitcnt lgkmcnt(2)
    v_mfma_f32_32x32x16_bf16 v[48:63], v[20:23], v[176:179], v[48:63]
    ds_read_b64_tr_b16 v[28:29], v6 offset:10240
    ds_read_b64_tr_b16 v[30:31], v6 offset:10752
    s_waitcnt vmcnt(18)
    s_waitcnt lgkmcnt(2)
    v_mfma_f32_32x32x16_bf16 v[32:47], v[24:27], v[180:183], v[32:47]
    s_waitcnt lgkmcnt(0)
    v_mfma_f32_32x32x16_bf16 v[48:63], v[28:31], v[180:183], v[48:63]
    v_add_u32 v5, 12288, v5
    v_add_u32 v6, 12288, v6
    s_barrier
    ds_read_b64_tr_b16 v[16:17], v5 offset:0
    ds_read_b64_tr_b16 v[18:19], v5 offset:512
    ds_read_b64_tr_b16 v[20:21], v6 offset:0
    ds_read_b64_tr_b16 v[22:23], v6 offset:512
    s_waitcnt vmcnt(17)
    s_waitcnt lgkmcnt(2)
    v_mfma_f32_32x32x16_bf16 v[32:47], v[16:19], v[184:187], v[32:47]
    ds_read_b64_tr_b16 v[24:25], v5 offset:2048
    ds_read_b64_tr_b16 v[26:27], v5 offset:2560
    s_waitcnt lgkmcnt(2)
    v_mfma_f32_32x32x16_bf16 v[48:63], v[20:23], v[184:187], v[48:63]
    ds_read_b64_tr_b16 v[28:29], v6 offset:2048
    ds_read_b64_tr_b16 v[30:31], v6 offset:2560
    s_waitcnt vmcnt(16)
    s_waitcnt lgkmcnt(2)
    v_mfma_f32_32x32x16_bf16 v[32:47], v[24:27], v[188:191], v[32:47]
    ds_read_b64_tr_b16 v[16:17], v5 offset:4096
    ds_read_b64_tr_b16 v[18:19], v5 offset:4608
    s_waitcnt lgkmcnt(2)
    v_mfma_f32_32x32x16_bf16 v[48:63], v[28:31], v[188:191], v[48:63]
    ds_read_b64_tr_b16 v[20:21], v6 offset:4096
    ds_read_b64_tr_b16 v[22:23], v6 offset:4608
    s_waitcnt vmcnt(12)
    s_waitcnt lgkmcnt(2)
    v_mfma_f32_32x32x16_bf16 v[32:47], v[16:19], v[192:195], v[32:47]
    ds_read_b64_tr_b16 v[24:25], v5 offset:6144
    ds_read_b64_tr_b16 v[26:27], v5 offset:6656
    s_waitcnt lgkmcnt(2)
    v_mfma_f32_32x32x16_bf16 v[48:63], v[20:23], v[192:195], v[48:63]
    ds_read_b64_tr_b16 v[28:29], v6 offset:6144
    ds_read_b64_tr_b16 v[30:31], v6 offset:6656
    s_waitcnt vmcnt(8)
    s_waitcnt lgkmcnt(2)
    v_mfma_f32_32x32x16_bf16 v[32:47], v[24:27], v[196:199], v[32:47]
    ds_read_b64_tr_b16 v[16:17], v5 offset:8192
    ds_read_b64_tr_b16 v[18:19], v5 offset:8704
    s_waitcnt lgkmcnt(2)
    v_mfma_f32_32x32x16_bf16 v[48:63], v[28:31], v[196:199], v[48:63]
    ds_read_b64_tr_b16 v[20:21], v6 offset:8192
    ds_read_b64_tr_b16 v[22:23], v6 offset:8704
    s_waitcnt vmcnt(4)
    s_waitcnt lgkmcnt(2)
    v_mfma_f32_32x32x16_bf16 v[32:47], v[16:19], v[200:203], v[32:47]
    ds_read_b64_tr_b16 v[24:25], v5 offset:10240
    ds_read_b64_tr_b16 v[26:27], v5 offset:10752
    s_waitcnt lgkmcnt(2)
    v_mfma_f32_32x32x16_bf16 v[48:63], v[20:23], v[200:203], v[48:63]
    ds_read_b64_tr_b16 v[28:29], v6 offset:10240
    ds_read_b64_tr_b16 v[30:31], v6 offset:10752
    s_waitcnt vmcnt(0)
    s_waitcnt lgkmcnt(2)
    v_mfma_f32_32x32x16_bf16 v[32:47], v[24:27], v[204:207], v[32:47]
    s_waitcnt lgkmcnt(0)
    v_mfma_f32_32x32x16_bf16 v[48:63], v[28:31], v[204:207], v[48:63]
    s_barrier
    s_lshl_b32 s26, s24, 13
    s_lshl_b32 s27, s23, 12
    s_add_u32 s28, s26, s27
    v_add_u32 v8, s28, v2
    s_xor_b32 s28, s28, 4096
    v_add_u32 v9, s28, v2
    s_nop 7
    s_cmp_eq_u32 s23, 0
    s_cbranch_scc1 k3_out_kernel_xa
    ds_write_b128 v8, v[32:35] offset:0
    ds_write_b128 v8, v[36:39] offset:1024
    ds_write_b128 v8, v[40:43] offset:2048
    ds_write_b128 v8, v[44:47] offset:3072
    v_mov_b32 v32, v48
    v_mov_b32 v33, v49
    v_mov_b32 v34, v50
    v_mov_b32 v35, v51
    v_mov_b32 v36, v52
    v_mov_b32 v37, v53
    v_mov_b32 v38, v54
    v_mov_b32 v39, v55
    v_mov_b32 v40, v56
    v_mov_b32 v41, v57
    v_mov_b32 v42, v58
    v_mov_b32 v43, v59
    v_mov_b32 v44, v60
    v_mov_b32 v45, v61
    v_mov_b32 v46, v62
    v_mov_b32 v47, v63
    s_branch k3_out_kernel_xb
k3_out_kernel_xa:
    ds_write_b128 v8, v[48:51] offset:0
    ds_write_b128 v8, v[52:55] offset:1024
    ds_write_b128 v8, v[56:59] offset:2048
    ds_write_b128 v8, v[60:63] offset:3072
k3_out_kernel_xb:
    s_waitcnt lgkmcnt(0)
    s_barrier
    ds_read_b128 v[64:67], v9 offset:0
    ds_read_b128 v[68:71], v9 offset:1024
    ds_read_b128 v[72:75], v9 offset:2048
    ds_read_b128 v[76:79], v9 offset:3072
    s_cmp_ge_u32 s25, 64
    s_cbranch_scc1 k3_out_kernel_end
    s_waitcnt lgkmcnt(0)
    v_add_f32 v32, v32, v64
    v_add_f32 v33, v33, v65
    v_add_f32 v34, v34, v66
    v_add_f32 v35, v35, v67
    v_add_f32 v36, v36, v68
    v_add_f32 v37, v37, v69
    v_add_f32 v38, v38, v70
    v_add_f32 v39, v39, v71
    v_add_f32 v40, v40, v72
    v_add_f32 v41, v41, v73
    v_add_f32 v42, v42, v74
    v_add_f32 v43, v43, v75
    v_add_f32 v44, v44, v76
    v_add_f32 v45, v45, v77
    v_add_f32 v46, v46, v78
    v_add_f32 v47, v47, v79
    v_cvt_pk_bf16_f32 v16, v32, v33
    v_cvt_pk_bf16_f32 v17, v34, v35
    v_cvt_pk_bf16_f32 v18, v36, v37
    v_cvt_pk_bf16_f32 v19, v38, v39
    v_cvt_pk_bf16_f32 v20, v40, v41
    v_cvt_pk_bf16_f32 v21, v42, v43
    v_cvt_pk_bf16_f32 v22, v44, v45
    v_cvt_pk_bf16_f32 v23, v46, v47
    v_and_b32 v10, 31, v1
    v_mul_u32_u24 v10, 1152, v10
    v_lshrrev_b32 v11, 5, v1
    v_lshl_add_u32 v10, v11, 4, v10
    s_mul_i32 s26, s25, 36864
    s_lshl_b32 s27, s21, 7
    s_add_u32 s26, s26, s27
    s_lshl_b32 s27, s23, 6
    s_add_u32 s26, s26, s27
    buffer_store_dwordx4 v[16:19], v10, s[16:19], s26 offen offset:0
    buffer_store_dwordx4 v[20:23], v10, s[16:19], s26 offen offset:32
k3_out_kernel_end:
    s_endpgm

.section .rodata,"a"
.p2align 6
.amdhsa_kernel k1_qkv_kernel
  .amdhsa_next_free_vgpr 128
  .amdhsa_next_free_sgpr 100
  .amdhsa_accum_offset 128
  .amdhsa_group_segment_fixed_size 0
  .amdhsa_kernarg_size 80
  .amdhsa_user_sgpr_count 2
  .amdhsa_user_sgpr_kernarg_segment_ptr 1
  .amdhsa_system_sgpr_workgroup_id_x 1
.end_amdhsa_kernel
.text
.section .rodata,"a"
.p2align 6
.amdhsa_kernel k2_attn_kernel
  .amdhsa_next_free_vgpr 164
  .amdhsa_next_free_sgpr 100
  .amdhsa_accum_offset 164
  .amdhsa_group_segment_fixed_size 0
  .amdhsa_kernarg_size 80
  .amdhsa_user_sgpr_count 2
  .amdhsa_user_sgpr_kernarg_segment_ptr 1
  .amdhsa_system_sgpr_workgroup_id_x 1
.end_amdhsa_kernel
.text
.section .rodata,"a"
.p2align 6
.amdhsa_kernel k3_out_kernel
  .amdhsa_next_free_vgpr 208
  .amdhsa_next_free_sgpr 100
  .amdhsa_accum_offset 208
  .amdhsa_group_segment_fixed_size 0
  .amdhsa_kernarg_size 80
  .amdhsa_user_sgpr_count 2
  .amdhsa_user_sgpr_kernarg_segment_ptr 1
  .amdhsa_system_sgpr_workgroup_id_x 1
.end_amdhsa_kernel
.text
```
